```python
import torch

def _softmax(x, axis=-1):
    return torch.softmax(x, dim=axis)
def _gelu(x):
    return torch.nn.functional.gelu(x, approximate="tanh")
def _silu(x):
    return torch.nn.functional.silu(x)
def _sigmoid(x):
    return torch.sigmoid(x)
def _layernorm(x, axis=-1, eps=1e-5):
    m = x.mean(dim=axis, keepdim=True)
    v = x.var(dim=axis, keepdim=True, unbiased=False)
    return (x - m) / torch.sqrt(v + eps)
def _scatter_add(tgt, idx, src, axis=0):
    return tgt.clone().index_add_(axis, idx, src)
def _segment_sum(src, seg, n):
    out = torch.zeros((n,) + src.shape[1:], dtype=src.dtype)
    return out.index_add_(0, seg, src)
def _pad(x, pw):
    flat = tuple(v for pair in reversed(pw) for v in pair)
    return torch.nn.functional.pad(x, flat)

kernel_name = 'recurrent_scan__sliding_block_cached__glu_gated_geglu__decode'

def setup_inputs():

    _w = (lambda a: (lambda t: t.to(torch.bfloat16) if t.is_floating_point() else t)(torch.as_tensor(a)))
    def _A_setup():
        B, Sq, D = 1, 1, 512
        Hq, Hkv, Sk, Dh = 32, 8, 65536, 128
        assert Hq % Hkv == 0, (Hq, Hkv)
        return {
            "x": _w((lambda *s: torch.randn(*s, dtype=torch.bfloat16) * 0.4)(B, Sq, D)),
            "k_cache": _w((lambda *s: torch.randn(*s, dtype=torch.bfloat16) * 1.6)(B, Hkv, Sk, Dh)),
            "v_cache": _w((lambda *s: torch.randn(*s, dtype=torch.bfloat16) * 1.6)(B, Hkv, Sk, Dh)),
            "wq": _w((lambda *s: torch.randn(*s, dtype=torch.bfloat16) * 1.6)(D, Hq * Dh) * (D ** -0.5)),
            "wo": _w((lambda *s: torch.randn(*s, dtype=torch.bfloat16) * 1.6)(Hq * Dh, D) * ((Hq * Dh) ** -0.5)),
        }
    _A_in = _A_setup()

    def _B_setup():
        B, S, Dm, Df = 1, 1, 512, 1792
        return {
            "x": _w((lambda *s: torch.randn(*s, dtype=torch.bfloat16) * 0.4)(B, S, Dm)),
            "w_gate": _w((lambda *s: torch.randn(*s, dtype=torch.bfloat16) * 1.6)(Dm, Df) * (Dm ** -0.5)),
            "w_up": _w((lambda *s: torch.randn(*s, dtype=torch.bfloat16) * 1.6)(Dm, Df) * (Dm ** -0.5)),
            "w_down": _w((lambda *s: torch.randn(*s, dtype=torch.bfloat16) * 1.6)(Df, Dm) * (Df ** -0.5)),
        }
    _B_in = _B_setup()

    return {
        "A_x": _A_in["x"],
        "A_k_cache": _A_in["k_cache"],
        "A_v_cache": _A_in["v_cache"],
        "A_wq": _A_in["wq"],
        "A_wo": _A_in["wo"],
        "B_x": _B_in["x"],
        "B_w_gate": _B_in["w_gate"],
        "B_w_up": _B_in["w_up"],
        "B_w_down": _B_in["w_down"],
    }

def reference(A_x, A_k_cache, A_v_cache, A_wq, A_wo, B_x, B_w_gate, B_w_up, B_w_down):
    def _A_ref(x, k_cache, v_cache, wq, wo):
        B, Sq, D = x.shape
        Hq, Dh = 32, 128
        Hkv, Sk = k_cache.shape[1], k_cache.shape[2]
        W = min(4096, max(256, Sk // 4))
        rep = Hq // Hkv
        q = (lambda x, *d: x.permute(*d))((x @ wq).reshape(B, Sq, Hq, Dh), 0, 2, 1, 3)
        k = (lambda x, n, axis: torch.repeat_interleave(x, n, dim=axis))(k_cache[:, :, Sk - W:, :], rep, axis=1)
        v = (lambda x, n, axis: torch.repeat_interleave(x, n, dim=axis))(v_cache[:, :, Sk - W:, :], rep, axis=1)
        scores = torch.einsum("bhqd,bhkd->bhqk", q, k) * (Dh ** -0.5)
        p = _softmax(scores, axis=-1)
        o = torch.einsum("bhqk,bhkd->bhqd", p, v)
        return (lambda x, *d: x.permute(*d))(o, 0, 2, 1, 3).reshape(B, Sq, Hq * Dh) @ wo

    def _B_ref(x, w_gate, w_up, w_down):
        g = torch.einsum("bsd,df->bsf", x, w_gate)
        u = torch.einsum("bsd,df->bsf", x, w_up)
        h = _gelu(g) * u
        return torch.einsum("bsf,fd->bsd", h, w_down)

    x = A_x
    xn = _layernorm(x, axis=-1)
    s = _A_ref(xn, A_k_cache, A_v_cache, A_wq, A_wo)
    g = _silu(_B_ref(xn, B_w_gate, B_w_up, B_w_down))
    return x + s * g
```

```asm
; @launch grid=(256,1,1) block=(512,1,1) lds=133120
.amdgcn_target "amdgcn-amd-amdhsa--gfx950"
.set SPIN, 0x40000
.text
.globl recurrent_scan__sliding_block_cached__glu_gated_geglu__decode_kernel
.p2align 8
.type recurrent_scan__sliding_block_cached__glu_gated_geglu__decode_kernel,@function
recurrent_scan__sliding_block_cached__glu_gated_geglu__decode_kernel:
    s_cmp_ge_u32 s2, 256
    s_cbranch_scc1 L_end0
    s_load_dwordx16 s[16:31], s[0:1], 0
    s_load_dwordx8 s[32:39], s[0:1], 64
    v_lshrrev_b32 v1, 6, v0
    v_lshlrev_b32 v2, 3, v0
    v_mov_b32 v8, 0
    v_mov_b32 v9, 0
    v_readfirstlane_b32 s3, v1
    v_add_u32 v2, 129024, v2
    v_and_b32 v0, 63, v0
    ds_write_b64 v2, v[8:9]
    s_and_b32 s4, s2, 7
    s_lshr_b32 s5, s2, 3
    v_and_b32 v4, 15, v0
    v_lshrrev_b32 v5, 4, v0
    v_mov_b32 v7, 131328
    s_cmp_eq_u32 s3, 0
    s_cbranch_scc1 L_ld
    s_cmp_eq_u32 s3, 1
    s_cbranch_scc1 L_qh
    s_mov_b32 s58, 0x20000000
    s_mov_b32 s59, 0x20000
    s_waitcnt lgkmcnt(0)
    s_load_dwordx2 s[40:41], s[38:39], 0
    s_mov_b32 s56, s38
    s_mov_b32 s57, s39
    s_getreg_b32 s44, hwreg(HW_REG_XCC_ID, 0, 4)
    s_barrier
    s_cmp_eq_u32 s3, 6
    s_cbranch_scc1 L_f
    s_cmp_eq_u32 s3, 7
    s_cbranch_scc1 L_o
    s_cmp_eq_u32 s3, 2
    s_cbranch_scc1 L_att
    s_mov_b64 exec, 0
    s_cmp_eq_u32 s3, 3
    s_cbranch_scc1 PAD_Q1
    s_cmp_eq_u32 s3, 4
    s_cbranch_scc1 PAD_Q2
    s_branch PAD_A1
L_end0:
    s_endpgm
L_qh:
    s_setprio 3
    v_lshlrev_b32 v2, 4, v0
    s_mov_b32 s50, 1024
    s_mov_b32 s51, 0x20000
    s_mov_b32 s58, 0x20000000
    s_mov_b32 s59, 0x20000
    s_waitcnt lgkmcnt(0)
    s_mov_b32 s48, s16
    s_mov_b32 s49, s17
    s_mov_b32 s56, s38
    s_mov_b32 s57, s39
    buffer_load_dwordx4 v[8:11], v2, s[48:51], 0 offen
    s_getreg_b32 s44, hwreg(HW_REG_XCC_ID, 0, 4)
    s_barrier
    s_branch L_q
L_ld:
    s_setprio 2
    v_lshrrev_b32 v6, 3, v0
    v_bfe_u32 v3, v0, 4, 1
    v_lshlrev_b32 v3, 1, v3
    v_and_b32 v8, 7, v0
    v_xor_b32 v8, v8, v3
    v_lshlrev_b32 v8, 4, v8
    v_lshl_or_b32 v10, v6, 13, v8
    v_xor_b32 v21, 64, v10
    v_lshrrev_b32 v9, 5, v0
    s_lshr_b32 s6, s5, 3
    s_lshl_b32 s6, s6, 20
    s_lshl_b32 s7, s4, 10
    s_add_u32 s6, s6, s7
    s_and_b32 s7, s5, 7
    s_lshl_b32 s7, s7, 7
    s_add_u32 s6, s6, s7
    s_mov_b32 s46, 0x400000
    s_mov_b32 s47, 0x20000
    s_mov_b32 m0, 0
    s_movk_i32 s42, 1024
    s_movk_i32 s43, 4096
    s_mov_b32 s40, 0x20000
    s_mov_b32 s41, 0x10000
    v_add_u32 v2, 0, v5
    v_xor_b32 v2, v4, v2
    v_lshlrev_b32 v2, 4, v2
    v_lshl_or_b32 v12, v5, 8, v2
    v_add_u32 v2, 4, v5
    v_xor_b32 v2, v4, v2
    v_lshlrev_b32 v2, 4, v2
    v_lshl_or_b32 v13, v5, 8, v2
    v_add_u32 v2, 8, v5
    v_xor_b32 v2, v4, v2
    v_lshlrev_b32 v2, 4, v2
    v_lshl_or_b32 v14, v5, 8, v2
    v_add_u32 v2, 12, v5
    v_xor_b32 v2, v4, v2
    v_lshlrev_b32 v2, 4, v2
    v_lshl_or_b32 v15, v5, 8, v2
    s_lshl_b32 s8, s4, 24
    s_lshl_b32 s7, s5, 12
    s_add_u32 s8, s8, s7
    s_add_u32 s8, s8, 0xf00000
    s_mov_b32 s9, s8
    s_mov_b32 s50, 0x8000000
    s_mov_b32 s51, 0x20000
    s_waitcnt lgkmcnt(0)
    s_mov_b32 s44, s22
    s_mov_b32 s45, s23
    s_mov_b32 s48, s18
    s_mov_b32 s49, s19
    buffer_load_dwordx4 v10, s[44:47], s6 offen nt lds
    s_add_u32 m0, m0, s42
    s_add_u32 s6, s6, s41
    buffer_load_dwordx4 v21, s[44:47], s6 offen nt lds
    s_add_u32 m0, m0, s42
    s_add_u32 s6, s6, s41
    buffer_load_dwordx4 v10, s[44:47], s6 offen nt lds
    s_add_u32 m0, m0, s42
    s_add_u32 s6, s6, s41
    buffer_load_dwordx4 v21, s[44:47], s6 offen nt lds
    s_add_u32 m0, m0, s42
    s_add_u32 s6, s6, s41
    buffer_load_dwordx4 v10, s[44:47], s6 offen nt lds
    s_add_u32 m0, m0, s42
    s_add_u32 s6, s6, s41
    buffer_load_dwordx4 v21, s[44:47], s6 offen nt lds
    s_barrier
    s_add_u32 m0, m0, s42
    s_add_u32 s6, s6, s41
    buffer_load_dwordx4 v10, s[44:47], s6 offen nt lds
    s_add_u32 m0, m0, s42
    s_add_u32 s6, s6, s41
    buffer_load_dwordx4 v21, s[44:47], s6 offen nt lds
    s_add_u32 m0, m0, s42
    s_add_u32 s6, s6, s41
    buffer_load_dwordx4 v10, s[44:47], s6 offen nt lds
    s_add_u32 m0, m0, s42
    s_add_u32 s6, s6, s41
    buffer_load_dwordx4 v21, s[44:47], s6 offen nt lds
    s_add_u32 m0, m0, s42
    s_add_u32 s6, s6, s41
    buffer_load_dwordx4 v10, s[44:47], s6 offen nt lds
    s_add_u32 m0, m0, s42
    s_add_u32 s6, s6, s41
    buffer_load_dwordx4 v21, s[44:47], s6 offen nt lds
    s_add_u32 m0, m0, s42
    s_add_u32 s6, s6, s41
    buffer_load_dwordx4 v10, s[44:47], s6 offen nt lds
    s_add_u32 m0, m0, s42
    s_add_u32 s6, s6, s41
    buffer_load_dwordx4 v21, s[44:47], s6 offen nt lds
    s_add_u32 m0, m0, s42
    s_add_u32 s6, s6, s41
    buffer_load_dwordx4 v10, s[44:47], s6 offen nt lds
    s_add_u32 m0, m0, s42
    s_add_u32 s6, s6, s41
    buffer_load_dwordx4 v21, s[44:47], s6 offen nt lds
    s_mov_b32 m0, 16384
    s_nop 0
    buffer_load_dwordx4 v12, s[48:51], s8 offen offset:0 nt lds
    buffer_load_dwordx4 v13, s[48:51], s8 offen offset:1024 nt lds
    buffer_load_dwordx4 v14, s[48:51], s8 offen offset:2048 nt lds
    buffer_load_dwordx4 v15, s[48:51], s8 offen offset:3072 nt lds
    s_add_u32 m0, m0, s43
    s_xor_b32 s8, s8, 0x21000
    buffer_load_dwordx4 v12, s[48:51], s8 offen offset:0 nt lds
    buffer_load_dwordx4 v13, s[48:51], s8 offen offset:1024 nt lds
    buffer_load_dwordx4 v14, s[48:51], s8 offen offset:2048 nt lds
    buffer_load_dwordx4 v15, s[48:51], s8 offen offset:3072 nt lds
    v_mul_u32_u24 v11, 3584, v6
    v_add_u32 v11, v11, v8
    v_xor_b32 v22, 64, v11
    v_add_u32 v2, 0, v5
    v_lshlrev_b32 v2, 1, v2
    v_xor_b32 v2, v4, v2
    v_lshlrev_b32 v2, 4, v2
    v_lshl_or_b32 v16, v5, 8, v2
    v_add_u32 v2, 4, v5
    v_lshlrev_b32 v2, 1, v2
    v_xor_b32 v2, v4, v2
    v_lshlrev_b32 v2, 4, v2
    v_lshl_or_b32 v17, v5, 8, v2
    v_and_b32 v3, 31, v0
    v_add_u32 v2, 0, v9
    v_lshlrev_b32 v2, 2, v2
    v_xor_b32 v2, v3, v2
    v_lshlrev_b32 v2, 4, v2
    v_lshl_or_b32 v18, v9, 10, v2
    v_add_u32 v2, 2, v9
    v_lshlrev_b32 v2, 2, v2
    v_xor_b32 v2, v3, v2
    v_lshlrev_b32 v2, 4, v2
    v_lshl_or_b32 v19, v9, 10, v2
    v_lshlrev_b32 v2, 2, v5
    v_xor_b32 v2, v4, v2
    v_lshlrev_b32 v2, 4, v2
    v_lshl_or_b32 v20, v5, 10, v2
    s_mov_b32 s52, s20
    s_mov_b32 s53, s21
    s_mov_b32 s54, 0x8000000
    s_mov_b32 s55, 0x20000
    s_bitcmp1_b32 s5, 2
    s_cselect_b32 s60, s30, s28
    s_cselect_b32 s61, s31, s29
    s_mov_b32 s62, 0x1c0000
    s_mov_b32 s63, 0x20000
    s_mov_b32 s68, s24
    s_mov_b32 s69, s25
    s_mov_b32 s70, 0x400000
    s_mov_b32 s71, 0x20000
    s_mov_b32 s72, s32
    s_mov_b32 s73, s33
    s_mov_b32 s74, 0x1c0000
    s_mov_b32 s75, 0x20000
    s_mov_b32 s56, s38
    s_mov_b32 s57, s39
    s_mov_b32 s58, 0x20000000
    s_mov_b32 s59, 0x20000
    s_and_b32 s14, s4, 3
    s_mul_i32 s14, s14, 14
    s_lshr_b32 s36, s4, 2
    s_lshl_b32 s7, s36, 3
    s_add_u32 s14, s14, s7
    s_lshr_b32 s7, s5, 2
    s_add_u32 s14, s14, s7
    s_and_b32 s15, s5, 3
    s_lshl_b32 s36, s36, 3
    s_add_u32 s36, s36, s5
    s_cmp_lt_u32 s36, 32
    s_cselect_b32 s36, 1, 0
    s_mul_i32 s10, s15, 458752
    s_lshl_b32 s7, s14, 6
    s_and_b32 s7, s7, -128
    s_add_u32 s10, s10, s7
    s_movk_i32 s41, 28672
    s_lshl_b32 s12, s4, 19
    s_lshr_b32 s7, s5, 1
    s_lshl_b32 s7, s7, 15
    s_add_u32 s12, s12, s7
    s_and_b32 s7, s5, 1
    s_lshl_b32 s7, s7, 9
    s_add_u32 s12, s12, s7
    s_lshl_b32 s13, s14, 15
    s_lshl_b32 s7, s15, 8
    s_add_u32 s13, s13, s7
    s_waitcnt vmcnt(23)
    s_add_u32 m0, m0, s43
    s_xor_b32 s8, s8, 0x63000
    buffer_load_dwordx4 v12, s[48:51], s8 offen offset:0 nt lds
    s_waitcnt vmcnt(22)
    buffer_load_dwordx4 v13, s[48:51], s8 offen offset:1024 nt lds
    s_waitcnt vmcnt(21)
    buffer_load_dwordx4 v14, s[48:51], s8 offen offset:2048 nt lds
    s_waitcnt vmcnt(20)
    buffer_load_dwordx4 v15, s[48:51], s8 offen offset:3072 nt lds
    s_waitcnt vmcnt(20)
    v_mov_b32 v2, 8
    ds_write_b32 v7, v2 offset:0
    s_waitcnt vmcnt(19)
    s_add_u32 m0, m0, s43
    s_xor_b32 s8, s8, 0x21000
    buffer_load_dwordx4 v12, s[48:51], s8 offen offset:0 nt lds
    s_waitcnt vmcnt(19)
    buffer_load_dwordx4 v13, s[48:51], s8 offen offset:1024 nt lds
    s_waitcnt vmcnt(19)
    buffer_load_dwordx4 v14, s[48:51], s8 offen offset:2048 nt lds
    s_waitcnt vmcnt(19)
    buffer_load_dwordx4 v15, s[48:51], s8 offen offset:3072 nt lds
    s_waitcnt vmcnt(19)
    s_mov_b32 m0, 32768
    s_xor_b32 s8, s8, 0xe7000
    buffer_load_dwordx4 v12, s[48:51], s8 offen offset:0 nt lds
    s_waitcnt vmcnt(19)
    buffer_load_dwordx4 v13, s[48:51], s8 offen offset:1024 nt lds
    s_waitcnt vmcnt(19)
    buffer_load_dwordx4 v14, s[48:51], s8 offen offset:2048 nt lds
    s_waitcnt vmcnt(19)
    buffer_load_dwordx4 v15, s[48:51], s8 offen offset:3072 nt lds
    v_mov_b32 v2, 16
    ds_write_b32 v7, v2 offset:0
    s_waitcnt vmcnt(19)
    s_add_u32 m0, m0, s43
    s_xor_b32 s8, s8, 0x21000
    buffer_load_dwordx4 v12, s[48:51], s8 offen offset:0 nt lds
    s_waitcnt vmcnt(19)
    buffer_load_dwordx4 v13, s[48:51], s8 offen offset:1024 nt lds
    s_waitcnt vmcnt(19)
    buffer_load_dwordx4 v14, s[48:51], s8 offen offset:2048 nt lds
    s_waitcnt vmcnt(19)
    buffer_load_dwordx4 v15, s[48:51], s8 offen offset:3072 nt lds
    s_waitcnt vmcnt(19)
    s_add_u32 m0, m0, s43
    s_xor_b32 s8, s8, 0x63000
    buffer_load_dwordx4 v12, s[48:51], s8 offen offset:0 nt lds
    s_waitcnt vmcnt(19)
    buffer_load_dwordx4 v13, s[48:51], s8 offen offset:1024 nt lds
    s_waitcnt vmcnt(19)
    buffer_load_dwordx4 v14, s[48:51], s8 offen offset:2048 nt lds
    s_waitcnt vmcnt(19)
    buffer_load_dwordx4 v15, s[48:51], s8 offen offset:3072 nt lds
    v_mov_b32 v2, 24
    ds_write_b32 v7, v2 offset:0
    s_waitcnt vmcnt(19)
    s_add_u32 m0, m0, s43
    s_xor_b32 s8, s8, 0x21000
    buffer_load_dwordx4 v12, s[48:51], s8 offen offset:0 nt lds
    s_waitcnt vmcnt(19)
    buffer_load_dwordx4 v13, s[48:51], s8 offen offset:1024 nt lds
    s_waitcnt vmcnt(19)
    buffer_load_dwordx4 v14, s[48:51], s8 offen offset:2048 nt lds
    s_waitcnt vmcnt(19)
    buffer_load_dwordx4 v15, s[48:51], s8 offen offset:3072 nt lds
    s_waitcnt vmcnt(19)
    s_mov_b32 m0, 49152
    s_nop 0
    buffer_load_dwordx4 v16, s[52:55], s9 offen offset:0 nt lds
    s_waitcnt vmcnt(19)
    buffer_load_dwordx4 v17, s[52:55], s9 offen offset:1024 nt lds
    s_waitcnt vmcnt(19)
    buffer_load_dwordx4 v16, s[52:55], s9 offen offset:2048 nt lds
    s_waitcnt vmcnt(19)
    buffer_load_dwordx4 v17, s[52:55], s9 offen offset:3072 nt lds
    v_mov_b32 v2, 32
    ds_write_b32 v7, v2 offset:0
    s_waitcnt vmcnt(19)
    s_add_u32 m0, m0, s43
    s_xor_b32 s9, s9, 0x21000
    buffer_load_dwordx4 v16, s[52:55], s9 offen offset:0 nt lds
    s_waitcnt vmcnt(19)
    buffer_load_dwordx4 v17, s[52:55], s9 offen offset:1024 nt lds
    s_waitcnt vmcnt(19)
    buffer_load_dwordx4 v16, s[52:55], s9 offen offset:2048 nt lds
    s_waitcnt vmcnt(19)
    buffer_load_dwordx4 v17, s[52:55], s9 offen offset:3072 nt lds
    s_waitcnt vmcnt(19)
    s_add_u32 m0, m0, s43
    s_xor_b32 s9, s9, 0x63000
    buffer_load_dwordx4 v16, s[52:55], s9 offen offset:0 nt lds
    s_waitcnt vmcnt(19)
    buffer_load_dwordx4 v17, s[52:55], s9 offen offset:1024 nt lds
    s_waitcnt vmcnt(19)
    buffer_load_dwordx4 v16, s[52:55], s9 offen offset:2048 nt lds
    s_waitcnt vmcnt(19)
    buffer_load_dwordx4 v17, s[52:55], s9 offen offset:3072 nt lds
    v_mov_b32 v2, 40
    ds_write_b32 v7, v2 offset:0
    s_waitcnt vmcnt(19)
    s_add_u32 m0, m0, s43
    s_xor_b32 s9, s9, 0x21000
    buffer_load_dwordx4 v16, s[52:55], s9 offen offset:0 nt lds
    s_waitcnt vmcnt(19)
    buffer_load_dwordx4 v17, s[52:55], s9 offen offset:1024 nt lds
    s_waitcnt vmcnt(19)
    buffer_load_dwordx4 v16, s[52:55], s9 offen offset:2048 nt lds
    s_waitcnt vmcnt(19)
    buffer_load_dwordx4 v17, s[52:55], s9 offen offset:3072 nt lds
    s_waitcnt vmcnt(19)
    s_mov_b32 m0, 65536
    s_xor_b32 s9, s9, 0xe7000
    buffer_load_dwordx4 v16, s[52:55], s9 offen offset:0 nt lds
    s_waitcnt vmcnt(19)
    buffer_load_dwordx4 v17, s[52:55], s9 offen offset:1024 nt lds
    s_waitcnt vmcnt(19)
    buffer_load_dwordx4 v16, s[52:55], s9 offen offset:2048 nt lds
    s_waitcnt vmcnt(19)
    buffer_load_dwordx4 v17, s[52:55], s9 offen offset:3072 nt lds
    v_mov_b32 v2, 48
    ds_write_b32 v7, v2 offset:0
    s_waitcnt vmcnt(19)
    s_add_u32 m0, m0, s43
    s_xor_b32 s9, s9, 0x21000
    buffer_load_dwordx4 v16, s[52:55], s9 offen offset:0 nt lds
    s_waitcnt vmcnt(19)
    buffer_load_dwordx4 v17, s[52:55], s9 offen offset:1024 nt lds
    s_waitcnt vmcnt(19)
    buffer_load_dwordx4 v16, s[52:55], s9 offen offset:2048 nt lds
    s_waitcnt vmcnt(19)
    buffer_load_dwordx4 v17, s[52:55], s9 offen offset:3072 nt lds
    s_waitcnt vmcnt(19)
    s_add_u32 m0, m0, s43
    s_xor_b32 s9, s9, 0x63000
    buffer_load_dwordx4 v16, s[52:55], s9 offen offset:0 nt lds
    s_waitcnt vmcnt(19)
    buffer_load_dwordx4 v17, s[52:55], s9 offen offset:1024 nt lds
    s_waitcnt vmcnt(19)
    buffer_load_dwordx4 v16, s[52:55], s9 offen offset:2048 nt lds
    s_waitcnt vmcnt(19)
    buffer_load_dwordx4 v17, s[52:55], s9 offen offset:3072 nt lds
    v_mov_b32 v2, 56
    ds_write_b32 v7, v2 offset:0
    s_waitcnt vmcnt(19)
    s_add_u32 m0, m0, s43
    s_xor_b32 s9, s9, 0x21000
    buffer_load_dwordx4 v16, s[52:55], s9 offen offset:0 nt lds
    s_waitcnt vmcnt(19)
    buffer_load_dwordx4 v17, s[52:55], s9 offen offset:1024 nt lds
    s_waitcnt vmcnt(19)
    buffer_load_dwordx4 v16, s[52:55], s9 offen offset:2048 nt lds
    s_waitcnt vmcnt(19)
    buffer_load_dwordx4 v17, s[52:55], s9 offen offset:3072 nt lds
    s_cmp_lg_u32 s36, 0
    s_cbranch_scc1 L_ld_full
    s_waitcnt vmcnt(19)
    s_mov_b32 m0, 98304
    s_nop 0
    buffer_load_dwordx4 v18, s[68:71], s12 offen nt lds
    s_waitcnt vmcnt(19)
    s_add_u32 m0, m0, s42
    s_add_u32 s12, s12, 0x800
    buffer_load_dwordx4 v19, s[68:71], s12 offen nt lds
    s_waitcnt vmcnt(19)
    s_add_u32 m0, m0, s42
    s_add_u32 s12, s12, 0x800
    buffer_load_dwordx4 v18, s[68:71], s12 offen nt lds
    s_waitcnt vmcnt(19)
    s_add_u32 m0, m0, s42
    s_add_u32 s12, s12, 0x800
    buffer_load_dwordx4 v19, s[68:71], s12 offen nt lds
    v_mov_b32 v2, 64
    ds_write_b32 v7, v2 offset:0
    s_waitcnt vmcnt(19)
    s_add_u32 m0, m0, s42
    s_add_u32 s12, s12, 0x800
    buffer_load_dwordx4 v18, s[68:71], s12 offen nt lds
    s_waitcnt vmcnt(19)
    s_add_u32 m0, m0, s42
    s_add_u32 s12, s12, 0x800
    buffer_load_dwordx4 v19, s[68:71], s12 offen nt lds
    s_waitcnt vmcnt(19)
    s_add_u32 m0, m0, s42
    s_add_u32 s12, s12, 0x800
    buffer_load_dwordx4 v18, s[68:71], s12 offen nt lds
    s_waitcnt vmcnt(19)
    s_add_u32 m0, m0, s42
    s_add_u32 s12, s12, 0x800
    buffer_load_dwordx4 v19, s[68:71], s12 offen nt lds
    s_waitcnt vmcnt(19)
    s_add_u32 m0, m0, s42
    s_add_u32 s12, s12, 0x800
    buffer_load_dwordx4 v18, s[68:71], s12 offen nt lds
    s_waitcnt vmcnt(19)
    s_add_u32 m0, m0, s42
    s_add_u32 s12, s12, 0x800
    buffer_load_dwordx4 v19, s[68:71], s12 offen nt lds
    s_waitcnt vmcnt(19)
    s_add_u32 m0, m0, s42
    s_add_u32 s12, s12, 0x800
    buffer_load_dwordx4 v18, s[68:71], s12 offen nt lds
    s_waitcnt vmcnt(19)
    s_add_u32 m0, m0, s42
    s_add_u32 s12, s12, 0x800
    buffer_load_dwordx4 v19, s[68:71], s12 offen nt lds
    v_mov_b32 v2, 72
    ds_write_b32 v7, v2 offset:0
    s_waitcnt vmcnt(19)
    s_add_u32 m0, m0, s42
    s_add_u32 s12, s12, 0x800
    buffer_load_dwordx4 v18, s[68:71], s12 offen nt lds
    s_waitcnt vmcnt(19)
    s_add_u32 m0, m0, s42
    s_add_u32 s12, s12, 0x800
    buffer_load_dwordx4 v19, s[68:71], s12 offen nt lds
    s_waitcnt vmcnt(19)
    s_add_u32 m0, m0, s42
    s_add_u32 s12, s12, 0x800
    buffer_load_dwordx4 v18, s[68:71], s12 offen nt lds
    s_waitcnt vmcnt(19)
    s_add_u32 m0, m0, s42
    s_add_u32 s12, s12, 0x800
    buffer_load_dwordx4 v19, s[68:71], s12 offen nt lds
    s_waitcnt vmcnt(16)
    v_mov_b32 v2, 80
    ds_write_b32 v7, v2 offset:0
    s_waitcnt vmcnt(0)
    v_mov_b32 v2, 112
    ds_write_b32 v7, v2 offset:0
    s_endpgm
L_ld_full:
    s_waitcnt vmcnt(19)
    s_mov_b32 m0, 81920
    s_nop 0
    buffer_load_dwordx4 v11, s[60:63], s10 offen nt lds
    s_waitcnt vmcnt(19)
    s_add_u32 m0, m0, s42
    s_add_u32 s10, s10, s41
    buffer_load_dwordx4 v22, s[60:63], s10 offen nt lds
    s_waitcnt vmcnt(19)
    s_add_u32 m0, m0, s42
    s_add_u32 s10, s10, s41
    buffer_load_dwordx4 v11, s[60:63], s10 offen nt lds
    s_waitcnt vmcnt(19)
    s_add_u32 m0, m0, s42
    s_add_u32 s10, s10, s41
    buffer_load_dwordx4 v22, s[60:63], s10 offen nt lds
    v_mov_b32 v2, 64
    ds_write_b32 v7, v2 offset:0
    s_waitcnt vmcnt(19)
    s_add_u32 m0, m0, s42
    s_add_u32 s10, s10, s41
    buffer_load_dwordx4 v11, s[60:63], s10 offen nt lds
    s_waitcnt vmcnt(19)
    s_add_u32 m0, m0, s42
    s_add_u32 s10, s10, s41
    buffer_load_dwordx4 v22, s[60:63], s10 offen nt lds
    s_waitcnt vmcnt(19)
    s_add_u32 m0, m0, s42
    s_add_u32 s10, s10, s41
    buffer_load_dwordx4 v11, s[60:63], s10 offen nt lds
    s_waitcnt vmcnt(19)
    s_add_u32 m0, m0, s42
    s_add_u32 s10, s10, s41
    buffer_load_dwordx4 v22, s[60:63], s10 offen nt lds
    s_waitcnt vmcnt(19)
    s_add_u32 m0, m0, s42
    s_add_u32 s10, s10, s41
    buffer_load_dwordx4 v11, s[60:63], s10 offen nt lds
    s_waitcnt vmcnt(19)
    s_add_u32 m0, m0, s42
    s_add_u32 s10, s10, s41
    buffer_load_dwordx4 v22, s[60:63], s10 offen nt lds
    s_waitcnt vmcnt(19)
    s_add_u32 m0, m0, s42
    s_add_u32 s10, s10, s41
    buffer_load_dwordx4 v11, s[60:63], s10 offen nt lds
    s_waitcnt vmcnt(19)
    s_add_u32 m0, m0, s42
    s_add_u32 s10, s10, s41
    buffer_load_dwordx4 v22, s[60:63], s10 offen nt lds
    v_mov_b32 v2, 72
    ds_write_b32 v7, v2 offset:0
    s_waitcnt vmcnt(19)
    s_add_u32 m0, m0, s42
    s_add_u32 s10, s10, s41
    buffer_load_dwordx4 v11, s[60:63], s10 offen nt lds
    s_waitcnt vmcnt(19)
    s_add_u32 m0, m0, s42
    s_add_u32 s10, s10, s41
    buffer_load_dwordx4 v22, s[60:63], s10 offen nt lds
    s_waitcnt vmcnt(19)
    s_add_u32 m0, m0, s42
    s_add_u32 s10, s10, s41
    buffer_load_dwordx4 v11, s[60:63], s10 offen nt lds
    s_waitcnt vmcnt(19)
    s_add_u32 m0, m0, s42
    s_add_u32 s10, s10, s41
    buffer_load_dwordx4 v22, s[60:63], s10 offen nt lds
    s_waitcnt vmcnt(19)
    s_mov_b32 m0, 98304
    s_nop 0
    buffer_load_dwordx4 v18, s[68:71], s12 offen nt lds
    s_waitcnt vmcnt(19)
    s_add_u32 m0, m0, s42
    s_add_u32 s12, s12, 0x800
    buffer_load_dwordx4 v19, s[68:71], s12 offen nt lds
    s_waitcnt vmcnt(19)
    s_add_u32 m0, m0, s42
    s_add_u32 s12, s12, 0x800
    buffer_load_dwordx4 v18, s[68:71], s12 offen nt lds
    s_waitcnt vmcnt(19)
    s_add_u32 m0, m0, s42
    s_add_u32 s12, s12, 0x800
    buffer_load_dwordx4 v19, s[68:71], s12 offen nt lds
    v_mov_b32 v2, 80
    ds_write_b32 v7, v2 offset:0
    s_waitcnt vmcnt(19)
    s_add_u32 m0, m0, s42
    s_add_u32 s12, s12, 0x800
    buffer_load_dwordx4 v18, s[68:71], s12 offen nt lds
    s_waitcnt vmcnt(19)
    s_add_u32 m0, m0, s42
    s_add_u32 s12, s12, 0x800
    buffer_load_dwordx4 v19, s[68:71], s12 offen nt lds
    s_waitcnt vmcnt(19)
    s_add_u32 m0, m0, s42
    s_add_u32 s12, s12, 0x800
    buffer_load_dwordx4 v18, s[68:71], s12 offen nt lds
    s_waitcnt vmcnt(19)
    s_add_u32 m0, m0, s42
    s_add_u32 s12, s12, 0x800
    buffer_load_dwordx4 v19, s[68:71], s12 offen nt lds
    s_waitcnt vmcnt(19)
    s_add_u32 m0, m0, s42
    s_add_u32 s12, s12, 0x800
    buffer_load_dwordx4 v18, s[68:71], s12 offen nt lds
    s_waitcnt vmcnt(19)
    s_add_u32 m0, m0, s42
    s_add_u32 s12, s12, 0x800
    buffer_load_dwordx4 v19, s[68:71], s12 offen nt lds
    s_waitcnt vmcnt(19)
    s_add_u32 m0, m0, s42
    s_add_u32 s12, s12, 0x800
    buffer_load_dwordx4 v18, s[68:71], s12 offen nt lds
    s_waitcnt vmcnt(19)
    s_add_u32 m0, m0, s42
    s_add_u32 s12, s12, 0x800
    buffer_load_dwordx4 v19, s[68:71], s12 offen nt lds
    v_mov_b32 v2, 88
    ds_write_b32 v7, v2 offset:0
    s_waitcnt vmcnt(19)
    s_add_u32 m0, m0, s42
    s_add_u32 s12, s12, 0x800
    buffer_load_dwordx4 v18, s[68:71], s12 offen nt lds
    s_waitcnt vmcnt(19)
    s_add_u32 m0, m0, s42
    s_add_u32 s12, s12, 0x800
    buffer_load_dwordx4 v19, s[68:71], s12 offen nt lds
    s_waitcnt vmcnt(19)
    s_add_u32 m0, m0, s42
    s_add_u32 s12, s12, 0x800
    buffer_load_dwordx4 v18, s[68:71], s12 offen nt lds
    s_waitcnt vmcnt(19)
    s_add_u32 m0, m0, s42
    s_add_u32 s12, s12, 0x800
    buffer_load_dwordx4 v19, s[68:71], s12 offen nt lds
    s_waitcnt vmcnt(19)
    s_mov_b32 m0, 114688
    s_nop 0
    buffer_load_dwordx4 v20, s[72:75], s13 offen nt lds
    s_waitcnt vmcnt(19)
    s_add_u32 m0, m0, s42
    s_add_u32 s13, s13, s43
    buffer_load_dwordx4 v20, s[72:75], s13 offen nt lds
    s_waitcnt vmcnt(19)
    s_add_u32 m0, m0, s42
    s_add_u32 s13, s13, s43
    buffer_load_dwordx4 v20, s[72:75], s13 offen nt lds
    s_waitcnt vmcnt(19)
    s_add_u32 m0, m0, s42
    s_add_u32 s13, s13, s43
    buffer_load_dwordx4 v20, s[72:75], s13 offen nt lds
    v_mov_b32 v2, 96
    ds_write_b32 v7, v2 offset:0
    s_waitcnt vmcnt(19)
    s_add_u32 m0, m0, s42
    s_add_u32 s13, s13, s43
    buffer_load_dwordx4 v20, s[72:75], s13 offen nt lds
    s_waitcnt vmcnt(19)
    s_add_u32 m0, m0, s42
    s_add_u32 s13, s13, s43
    buffer_load_dwordx4 v20, s[72:75], s13 offen nt lds
    s_waitcnt vmcnt(19)
    s_add_u32 m0, m0, s42
    s_add_u32 s13, s13, s43
    buffer_load_dwordx4 v20, s[72:75], s13 offen nt lds
    s_waitcnt vmcnt(19)
    s_add_u32 m0, m0, s42
    s_add_u32 s13, s13, s43
    buffer_load_dwordx4 v20, s[72:75], s13 offen nt lds
    s_waitcnt vmcnt(8)
    v_mov_b32 v2, 112
    ds_write_b32 v7, v2 offset:0
    s_waitcnt vmcnt(0)
    v_mov_b32 v2, 120
    ds_write_b32 v7, v2 offset:0
    s_endpgm
.p2align 12
L_q:
    v_add_u32 v12, 122880, v2
    s_lshr_b32 s6, s5, 3
    s_lshl_b32 s6, s6, 8
    s_add_u32 s6, s6, 122880
    v_lshlrev_b32 v13, 4, v5
    v_add_u32 v13, s6, v13
    v_lshrrev_b32 v3, 2, v4
    v_lshl_add_u32 v3, v5, 3, v3
    v_lshlrev_b32 v3, 7, v3
    v_bfe_u32 v6, v0, 3, 2
    v_lshl_or_b32 v3, v6, 5, v3
    v_and_b32 v6, 3, v0
    v_lshl_or_b32 v120, v6, 3, v3
    v_xor_b32 v121, 32, v120
    v_xor_b32 v122, 64, v120
    v_xor_b32 v123, 96, v120
    s_lshl_b32 s14, s4, 14
    s_lshl_b32 s15, s5, 9
    s_add_u32 s15, s15, s14
    s_add_u32 s15, s15, 0x200000
    v_lshrrev_b32 v3, 1, v4
    v_lshlrev_b32 v3, 7, v3
    v_lshl_or_b32 v3, v5, 5, v3
    v_and_b32 v6, 1, v0
    v_lshl_or_b32 v3, v6, 4, v3
    s_mov_b32 s8, 0xaaaaaaaa
    s_mov_b32 s9, 0xaaaaaaaa
    s_mov_b32 s10, 0xcccccccc
    s_mov_b32 s11, 0xcccccccc
    s_mov_b32 s12, 0xf0f0f0f0
    s_mov_b32 s13, 0xf0f0f0f0
    v_mov_b32 v149, 1
    s_mov_b32 s52, s34
    s_mov_b32 s53, s35
    s_mov_b32 s54, 1024
    s_mov_b32 s55, 0x20000
    s_waitcnt vmcnt(0)
    v_lshlrev_b32 v80, 16, v8
    v_and_b32 v81, 0xffff0000, v8
    v_lshlrev_b32 v82, 16, v9
    v_and_b32 v83, 0xffff0000, v9
    v_lshlrev_b32 v84, 16, v10
    v_and_b32 v85, 0xffff0000, v10
    v_lshlrev_b32 v86, 16, v11
    v_and_b32 v87, 0xffff0000, v11
    v_add_f32 v88, v80, v81
    v_add_f32 v89, v82, v83
    v_add_f32 v90, v84, v85
    v_add_f32 v91, v86, v87
    v_add_f32 v88, v88, v89
    v_add_f32 v90, v90, v91
    v_add_f32 v88, v88, v90
    s_nop 1
    v_add_f32_dpp v88, v88, v88 row_ror:1 row_mask:0xf bank_mask:0xf
    s_nop 1
    v_add_f32_dpp v88, v88, v88 row_ror:2 row_mask:0xf bank_mask:0xf
    s_nop 1
    v_add_f32_dpp v88, v88, v88 row_ror:4 row_mask:0xf bank_mask:0xf
    s_nop 1
    v_add_f32_dpp v88, v88, v88 row_ror:8 row_mask:0xf bank_mask:0xf
    v_mov_b32 v89, v88
    s_nop 1
    v_permlane16_swap_b32 v88, v89
    v_add_f32 v88, v88, v89
    v_mov_b32 v89, v88
    s_nop 1
    v_permlane32_swap_b32 v88, v89
    v_add_f32 v88, v88, v89
    v_mul_f32 v88, 0x3b000000, v88
    v_sub_f32 v90, v80, v88
    v_mul_f32 v89, v90, v90
    v_sub_f32 v90, v81, v88
    v_fmac_f32 v89, v90, v90
    v_sub_f32 v90, v82, v88
    v_fmac_f32 v89, v90, v90
    v_sub_f32 v90, v83, v88
    v_fmac_f32 v89, v90, v90
    v_sub_f32 v90, v84, v88
    v_fmac_f32 v89, v90, v90
    v_sub_f32 v90, v85, v88
    v_fmac_f32 v89, v90, v90
    v_sub_f32 v90, v86, v88
    v_fmac_f32 v89, v90, v90
    v_sub_f32 v90, v87, v88
    v_fmac_f32 v89, v90, v90
    s_nop 1
    v_add_f32_dpp v89, v89, v89 row_ror:1 row_mask:0xf bank_mask:0xf
    s_nop 1
    v_add_f32_dpp v89, v89, v89 row_ror:2 row_mask:0xf bank_mask:0xf
    s_nop 1
    v_add_f32_dpp v89, v89, v89 row_ror:4 row_mask:0xf bank_mask:0xf
    s_nop 1
    v_add_f32_dpp v89, v89, v89 row_ror:8 row_mask:0xf bank_mask:0xf
    v_mov_b32 v90, v89
    s_nop 1
    v_permlane16_swap_b32 v89, v90
    v_add_f32 v89, v89, v90
    v_mov_b32 v90, v89
    s_nop 1
    v_permlane32_swap_b32 v89, v90
    v_add_f32 v89, v89, v90
    v_mul_f32 v89, 0x3b000000, v89
    v_cvt_pk_bf16_f32 v90, v88, v89
    v_lshlrev_b32 v88, 16, v90
    v_and_b32 v89, 0xffff0000, v90
    v_add_f32 v89, 0x3727c5ac, v89
    v_cvt_pk_bf16_f32 v90, v89, v89
    v_lshlrev_b32 v89, 16, v90
    v_sqrt_f32 v89, v89
    s_nop 0
    v_cvt_pk_bf16_f32 v90, v89, v89
    v_lshlrev_b32 v89, 16, v90
    v_rcp_f32 v90, v89
    v_sub_f32 v80, v80, v88
    v_sub_f32 v81, v81, v88
    v_sub_f32 v82, v82, v88
    v_sub_f32 v83, v83, v88
    v_sub_f32 v84, v84, v88
    v_sub_f32 v85, v85, v88
    v_sub_f32 v86, v86, v88
    v_sub_f32 v87, v87, v88
    v_cvt_pk_bf16_f32 v96, v80, v81
    v_cvt_pk_bf16_f32 v97, v82, v83
    v_cvt_pk_bf16_f32 v98, v84, v85
    v_cvt_pk_bf16_f32 v99, v86, v87
    v_lshlrev_b32 v80, 16, v96
    v_and_b32 v81, 0xffff0000, v96
    v_lshlrev_b32 v82, 16, v97
    v_and_b32 v83, 0xffff0000, v97
    v_lshlrev_b32 v84, 16, v98
    v_and_b32 v85, 0xffff0000, v98
    v_lshlrev_b32 v86, 16, v99
    v_and_b32 v87, 0xffff0000, v99
    v_mul_f32 v91, v80, v90
    v_fma_f32 v92, -v91, v89, v80
    v_fma_f32 v80, v92, v90, v91
    v_mul_f32 v91, v81, v90
    v_fma_f32 v92, -v91, v89, v81
    v_fma_f32 v81, v92, v90, v91
    v_mul_f32 v91, v82, v90
    v_fma_f32 v92, -v91, v89, v82
    v_fma_f32 v82, v92, v90, v91
    v_mul_f32 v91, v83, v90
    v_fma_f32 v92, -v91, v89, v83
    v_fma_f32 v83, v92, v90, v91
    v_mul_f32 v91, v84, v90
    v_fma_f32 v92, -v91, v89, v84
    v_fma_f32 v84, v92, v90, v91
    v_mul_f32 v91, v85, v90
    v_fma_f32 v92, -v91, v89, v85
    v_fma_f32 v85, v92, v90, v91
    v_mul_f32 v91, v86, v90
    v_fma_f32 v92, -v91, v89, v86
    v_fma_f32 v86, v92, v90, v91
    v_mul_f32 v91, v87, v90
    v_fma_f32 v92, -v91, v89, v87
    v_fma_f32 v87, v92, v90, v91
    v_cvt_pk_bf16_f32 v96, v80, v81
    v_cvt_pk_bf16_f32 v97, v82, v83
    v_cvt_pk_bf16_f32 v98, v84, v85
    v_cvt_pk_bf16_f32 v99, v86, v87
    ds_write_b128 v12, v[96:99]
    ds_write_b32 v7, v149 offset:4
PAD_Q1:
    s_cbranch_execz L_att_x
    ds_read_b128 v[100:103], v13 offset:0
    ds_read_b128 v[104:107], v13 offset:64
    ds_read_b128 v[108:111], v13 offset:128
    ds_read_b128 v[112:115], v13 offset:192
    s_mov_b32 s64, SPIN
L_w_1:
    ds_read_b32 v80, v7 offset:0
    s_waitcnt lgkmcnt(0)
    v_cmp_gt_u32 vcc, 8, v80
    s_cbranch_vccz L_w_1_ok
    s_sub_u32 s64, s64, 1
    s_cbranch_scc1 L_end
    s_branch L_w_1
L_w_1_ok:
    ds_read_b64_tr_b16 v[16:17], v120 offset:0
    ds_read_b64_tr_b16 v[18:19], v120 offset:512
    ds_read_b64_tr_b16 v[20:21], v121 offset:0
    ds_read_b64_tr_b16 v[22:23], v121 offset:512
    ds_read_b64_tr_b16 v[24:25], v122 offset:0
    ds_read_b64_tr_b16 v[26:27], v122 offset:512
    ds_read_b64_tr_b16 v[28:29], v123 offset:0
    ds_read_b64_tr_b16 v[30:31], v123 offset:512
    ds_read_b64_tr_b16 v[32:33], v120 offset:4096
    ds_read_b64_tr_b16 v[34:35], v120 offset:4608
    ds_read_b64_tr_b16 v[36:37], v121 offset:4096
    ds_read_b64_tr_b16 v[38:39], v121 offset:4608
    ds_read_b64_tr_b16 v[40:41], v122 offset:4096
    ds_read_b64_tr_b16 v[42:43], v122 offset:4608
    ds_read_b64_tr_b16 v[44:45], v123 offset:4096
    ds_read_b64_tr_b16 v[46:47], v123 offset:4608
    s_waitcnt lgkmcnt(12)
    v_mfma_f32_16x16x32_bf16 v[132:135], v[16:19], v[100:103], 0
    v_mfma_f32_16x16x32_bf16 v[136:139], v[20:23], v[100:103], 0
    s_waitcnt lgkmcnt(8)
    v_mfma_f32_16x16x32_bf16 v[140:143], v[24:27], v[100:103], 0
    v_mfma_f32_16x16x32_bf16 v[144:147], v[28:31], v[100:103], 0
    s_waitcnt lgkmcnt(4)
    v_mfma_f32_16x16x32_bf16 v[132:135], v[32:35], v[104:107], v[132:135]
    v_mfma_f32_16x16x32_bf16 v[136:139], v[36:39], v[104:107], v[136:139]
    s_waitcnt lgkmcnt(0)
    v_mfma_f32_16x16x32_bf16 v[140:143], v[40:43], v[104:107], v[140:143]
    v_mfma_f32_16x16x32_bf16 v[144:147], v[44:47], v[104:107], v[144:147]
    s_mov_b32 s64, SPIN
L_w_2:
    ds_read_b32 v80, v7 offset:0
    s_waitcnt lgkmcnt(0)
    v_cmp_gt_u32 vcc, 16, v80
    s_cbranch_vccz L_w_2_ok
    s_sub_u32 s64, s64, 1
    s_cbranch_scc1 L_end
    s_branch L_w_2
L_w_2_ok:
    ds_read_b64_tr_b16 v[48:49], v120 offset:8192
    ds_read_b64_tr_b16 v[50:51], v120 offset:8704
    ds_read_b64_tr_b16 v[52:53], v121 offset:8192
    ds_read_b64_tr_b16 v[54:55], v121 offset:8704
    ds_read_b64_tr_b16 v[56:57], v122 offset:8192
    ds_read_b64_tr_b16 v[58:59], v122 offset:8704
    ds_read_b64_tr_b16 v[60:61], v123 offset:8192
    ds_read_b64_tr_b16 v[62:63], v123 offset:8704
    ds_read_b64_tr_b16 v[64:65], v120 offset:12288
    ds_read_b64_tr_b16 v[66:67], v120 offset:12800
    ds_read_b64_tr_b16 v[68:69], v121 offset:12288
    ds_read_b64_tr_b16 v[70:71], v121 offset:12800
    ds_read_b64_tr_b16 v[72:73], v122 offset:12288
    ds_read_b64_tr_b16 v[74:75], v122 offset:12800
    ds_read_b64_tr_b16 v[76:77], v123 offset:12288
    ds_read_b64_tr_b16 v[78:79], v123 offset:12800
    ds_read_b96 v[150:152], v7 offset:16
    s_waitcnt lgkmcnt(13)
    v_mfma_f32_16x16x32_bf16 v[132:135], v[48:51], v[108:111], v[132:135]
    v_mfma_f32_16x16x32_bf16 v[136:139], v[52:55], v[108:111], v[136:139]
    s_waitcnt lgkmcnt(9)
    v_mfma_f32_16x16x32_bf16 v[140:143], v[56:59], v[108:111], v[140:143]
    v_mfma_f32_16x16x32_bf16 v[144:147], v[60:63], v[108:111], v[144:147]
    s_waitcnt lgkmcnt(5)
    v_mfma_f32_16x16x32_bf16 v[132:135], v[64:67], v[112:115], v[132:135]
    v_mfma_f32_16x16x32_bf16 v[136:139], v[68:71], v[112:115], v[136:139]
    s_waitcnt lgkmcnt(1)
    v_mfma_f32_16x16x32_bf16 v[140:143], v[72:75], v[112:115], v[140:143]
    v_mfma_f32_16x16x32_bf16 v[144:147], v[76:79], v[112:115], v[144:147]
    s_mov_b32 s64, SPIN
PAD_Q2:
    s_cbranch_execz L_att_x
L_q_tw:
    s_waitcnt lgkmcnt(0)
    v_cmp_eq_u32 vcc, 0, v152
    s_cbranch_vccz L_q_tok
    ds_read_b96 v[150:152], v7 offset:16
    s_sub_u32 s64, s64, 1
    s_cbranch_scc1 L_end
    s_branch L_q_tw
L_q_tok:
    v_or_b32 v158, s44, v150
    v_mov_b32 v159, v151
    v_readfirstlane_b32 s40, v150
    v_readfirstlane_b32 s41, v151
    v_cndmask_b32_e64 v80, v132, v134, s[8:9]
    v_cndmask_b32_e64 v81, v133, v135, s[8:9]
    v_cndmask_b32_e64 v82, v136, v138, s[8:9]
    v_cndmask_b32_e64 v83, v137, v139, s[8:9]
    v_cndmask_b32_e64 v84, v140, v142, s[8:9]
    v_cndmask_b32_e64 v85, v141, v143, s[8:9]
    v_cndmask_b32_e64 v86, v144, v146, s[8:9]
    v_cndmask_b32_e64 v87, v145, v147, s[8:9]
    v_cndmask_b32_e64 v80, v80, v82, s[10:11]
    v_cndmask_b32_e64 v81, v81, v83, s[10:11]
    v_cndmask_b32_e64 v84, v84, v86, s[10:11]
    v_cndmask_b32_e64 v85, v85, v87, s[10:11]
    s_mov_b32 exec_lo, 0x00ff00ff
    s_mov_b32 exec_hi, 0x00ff00ff
    v_cndmask_b32_e64 v156, v80, v84, s[12:13]
    v_cndmask_b32_e64 v157, v81, v85, s[12:13]
    buffer_store_dwordx4 v[156:159], v3, s[56:59], s15 offen
    ds_write_b32 v7, v149 offset:36
    s_setprio 0
    s_mov_b32 s64, SPIN
L_q_w:
    s_sleep 4
    ds_read_b64 v[80:81], v7 offset:8
    s_sub_u32 s64, s64, 1
    s_cbranch_scc1 L_end
    s_waitcnt lgkmcnt(0)
    v_cmp_ne_u32 vcc, 0, v81
    s_cbranch_vccnz L_q_slow
    v_and_b32 v80, 7, v80
    v_cmp_ne_u32 vcc, 4, v80
    s_cbranch_vccnz L_q_w
    s_branch L_q_dd
L_q_slow:
    s_add_u32 s15, s15, 0x20000
    buffer_store_dwordx4 v[156:159], v3, s[56:59], s15 offen sc1
L_q_dd:
    s_mov_b64 exec, -1
    s_lshr_b32 s6, s4, 2
    s_lshl_b32 s6, s6, 3
    s_add_u32 s6, s6, s5
    s_cmp_ge_u32 s6, 32
    s_cbranch_scc1 L_fin
    s_cmp_lg_u32 s5, 16
    s_cbranch_scc1 L_q_nwb
    s_mov_b32 s64, SPIN
L_w_3:
    ds_read_b32 v160, v7 offset:40
    s_waitcnt lgkmcnt(0)
    v_cmp_gt_u32 vcc, 1, v160
    s_cbranch_vccz L_w_3_ok
    s_sleep 4
    s_sub_u32 s64, s64, 1
    s_cbranch_scc1 L_end
    s_branch L_w_3
L_w_3_ok:
    buffer_wbl2 sc1
L_q_nwb:
    s_endpgm
.p2align 12
L_fin:
    s_setprio 1
    s_and_b32 s6, s4, 3
    s_lshl_b32 s6, s6, 3
    s_add_u32 s6, s6, s5
    s_sub_u32 s6, s6, 24
    s_lshl_b32 s6, s6, 1
    s_lshr_b32 s7, s3, 2
    s_add_u32 s6, s6, s7
    s_mov_b32 s65, s6
    s_lshl_b32 s12, s6, 13
    s_add_u32 s12, s12, 0x80000
    s_add_u32 s13, s12, 4096
    s_mul_i32 s14, s6, 3584
    s_add_u32 s14, s14, 0x41000
    s_lshl_b32 s15, s6, 4
    v_and_b32 v3, 3, v0
    v_lshlrev_b32 v3, 2, v3
    v_add_u32 v3, s15, v3
    s_waitcnt vmcnt(0)
    buffer_load_dword v6, v3, s[48:51], 0 offen
    s_mov_b64 s[16:17], -1
    s_mov_b64 s[18:19], -1
    s_mov_b64 s[20:21], -1
    s_mov_b64 s[22:23], -1
    s_mov_b64 s[24:25], -1
    s_mov_b64 s[26:27], -1
    s_mov_b64 s[28:29], -1
    s_mov_b64 s[30:31], -1
    s_mov_b64 s[32:33], -1
    s_mov_b64 s[34:35], -1
    s_mov_b64 s[36:37], -1
    s_mov_b64 s[38:39], -1
    s_mov_b32 s39, 0
    v_mov_b32 v60, 0
    v_mov_b32 v61, 0
    s_mov_b64 s[42:43], -1
    s_mov_b64 s[44:45], -1
    s_mov_b64 s[46:47], -1
    s_mov_b64 s[66:67], -1
    s_mov_b64 s[68:69], -1
    s_mov_b64 s[70:71], -1
    s_mov_b64 s[72:73], -1
    s_mov_b64 s[74:75], -1
    s_mov_b64 s[94:95], -1
    s_mov_b64 s[96:97], -1
    s_mov_b64 s[98:99], -1
    s_mov_b64 s[100:101], -1
    s_mov_b32 s101, 0
    v_mov_b32 v108, 0
    v_mov_b32 v109, 0
    s_mov_b32 s64, SPIN
L_w_4:
    ds_read_b32 v160, v7 offset:32
    s_waitcnt lgkmcnt(0)
    v_cmp_gt_u32 vcc, 1, v160
    s_cbranch_vccz L_w_4_ok
    s_sleep 2
    s_sub_u32 s64, s64, 1
    s_cbranch_scc1 L_end
    s_branch L_w_4
L_w_4_ok:
    s_setprio 3
    s_mov_b32 s64, SPIN
    s_sleep 20
    s_mov_b64 exec, s[16:17]
    buffer_load_dwordx4 v[16:19], v2, s[56:59], s12 offen offset:0 sc1
    s_mov_b64 exec, s[18:19]
    buffer_load_dwordx4 v[20:23], v2, s[56:59], s12 offen offset:1024 sc1
    s_mov_b64 exec, s[20:21]
    buffer_load_dwordx4 v[24:27], v2, s[56:59], s12 offen offset:2048 sc1
    s_mov_b64 exec, s[22:23]
    buffer_load_dwordx4 v[28:31], v2, s[56:59], s12 offen offset:3072 sc1
    s_mov_b64 exec, s[24:25]
    buffer_load_dwordx4 v[32:35], v2, s[56:59], s13 offen offset:0 sc1
    s_mov_b64 exec, s[26:27]
    buffer_load_dwordx4 v[36:39], v2, s[56:59], s13 offen offset:1024 sc1
    s_mov_b64 exec, s[28:29]
    buffer_load_dwordx4 v[40:43], v2, s[56:59], s13 offen offset:2048 sc1
    s_mov_b64 exec, s[30:31]
    buffer_load_dwordx4 v[44:47], v2, s[56:59], s13 offen offset:3072 sc1
    s_mov_b64 exec, s[32:33]
    buffer_load_dwordx4 v[48:51], v2, s[56:59], s14 offen offset:0 sc1
    s_mov_b64 exec, s[34:35]
    buffer_load_dwordx4 v[52:55], v2, s[56:59], s14 offen offset:1024 sc1
    s_mov_b64 exec, s[36:37]
    buffer_load_dwordx4 v[56:59], v2, s[56:59], s14 offen offset:2048 sc1
    s_mov_b64 exec, s[38:39]
    buffer_load_dwordx4 v[60:63], v2, s[56:59], s14 offen offset:3072 sc1
    s_mov_b64 exec, -1
    s_sleep 8
    s_mov_b64 exec, s[42:43]
    buffer_load_dwordx4 v[64:67], v2, s[56:59], s12 offen offset:0 sc1
    s_mov_b64 exec, s[44:45]
    buffer_load_dwordx4 v[68:71], v2, s[56:59], s12 offen offset:1024 sc1
    s_mov_b64 exec, s[46:47]
    buffer_load_dwordx4 v[72:75], v2, s[56:59], s12 offen offset:2048 sc1
    s_mov_b64 exec, s[66:67]
    buffer_load_dwordx4 v[76:79], v2, s[56:59], s12 offen offset:3072 sc1
    s_mov_b64 exec, s[68:69]
    buffer_load_dwordx4 v[80:83], v2, s[56:59], s13 offen offset:0 sc1
    s_mov_b64 exec, s[70:71]
    buffer_load_dwordx4 v[84:87], v2, s[56:59], s13 offen offset:1024 sc1
    s_mov_b64 exec, s[72:73]
    buffer_load_dwordx4 v[88:91], v2, s[56:59], s13 offen offset:2048 sc1
    s_mov_b64 exec, s[74:75]
    buffer_load_dwordx4 v[92:95], v2, s[56:59], s13 offen offset:3072 sc1
    s_mov_b64 exec, s[94:95]
    buffer_load_dwordx4 v[96:99], v2, s[56:59], s14 offen offset:0 sc1
    s_mov_b64 exec, s[96:97]
    buffer_load_dwordx4 v[100:103], v2, s[56:59], s14 offen offset:1024 sc1
    s_mov_b64 exec, s[98:99]
    buffer_load_dwordx4 v[104:107], v2, s[56:59], s14 offen offset:2048 sc1
    s_mov_b64 exec, s[100:101]
    buffer_load_dwordx4 v[108:111], v2, s[56:59], s14 offen offset:3072 sc1
    s_mov_b64 exec, -1
L_f_poll3:
    s_waitcnt vmcnt(12)
    v_cmp_ne_u64 s[16:17], s[40:41], v[18:19]
    v_cmp_ne_u64 s[18:19], s[40:41], v[22:23]
    v_cmp_ne_u64 s[20:21], s[40:41], v[26:27]
    v_cmp_ne_u64 s[22:23], s[40:41], v[30:31]
    v_cmp_ne_u64 s[24:25], s[40:41], v[34:35]
    v_cmp_ne_u64 s[26:27], s[40:41], v[38:39]
    v_cmp_ne_u64 s[28:29], s[40:41], v[42:43]
    v_cmp_ne_u64 s[30:31], s[40:41], v[46:47]
    v_cmp_ne_u64 s[32:33], s[40:41], v[50:51]
    v_cmp_ne_u64 s[34:35], s[40:41], v[54:55]
    v_cmp_ne_u64 s[36:37], s[40:41], v[58:59]
    v_cmp_ne_u64 s[38:39], s[40:41], v[62:63]
    s_mov_b32 s39, 0
    s_or_b64 s[60:61], s[16:17], 0
    s_or_b64 s[60:61], s[18:19], s[60:61]
    s_or_b64 s[60:61], s[20:21], s[60:61]
    s_or_b64 s[60:61], s[22:23], s[60:61]
    s_or_b64 s[60:61], s[24:25], s[60:61]
    s_or_b64 s[60:61], s[26:27], s[60:61]
    s_or_b64 s[60:61], s[28:29], s[60:61]
    s_or_b64 s[60:61], s[30:31], s[60:61]
    s_or_b64 s[60:61], s[32:33], s[60:61]
    s_or_b64 s[60:61], s[34:35], s[60:61]
    s_or_b64 s[60:61], s[36:37], s[60:61]
    s_or_b64 s[60:61], s[38:39], s[60:61]
    s_cbranch_scc0 L_fin_d0
    s_mov_b64 exec, s[16:17]
    buffer_load_dwordx4 v[16:19], v2, s[56:59], s12 offen offset:0 sc1
    s_mov_b64 exec, s[18:19]
    buffer_load_dwordx4 v[20:23], v2, s[56:59], s12 offen offset:1024 sc1
    s_mov_b64 exec, s[20:21]
    buffer_load_dwordx4 v[24:27], v2, s[56:59], s12 offen offset:2048 sc1
    s_mov_b64 exec, s[22:23]
    buffer_load_dwordx4 v[28:31], v2, s[56:59], s12 offen offset:3072 sc1
    s_mov_b64 exec, s[24:25]
    buffer_load_dwordx4 v[32:35], v2, s[56:59], s13 offen offset:0 sc1
    s_mov_b64 exec, s[26:27]
    buffer_load_dwordx4 v[36:39], v2, s[56:59], s13 offen offset:1024 sc1
    s_mov_b64 exec, s[28:29]
    buffer_load_dwordx4 v[40:43], v2, s[56:59], s13 offen offset:2048 sc1
    s_mov_b64 exec, s[30:31]
    buffer_load_dwordx4 v[44:47], v2, s[56:59], s13 offen offset:3072 sc1
    s_mov_b64 exec, s[32:33]
    buffer_load_dwordx4 v[48:51], v2, s[56:59], s14 offen offset:0 sc1
    s_mov_b64 exec, s[34:35]
    buffer_load_dwordx4 v[52:55], v2, s[56:59], s14 offen offset:1024 sc1
    s_mov_b64 exec, s[36:37]
    buffer_load_dwordx4 v[56:59], v2, s[56:59], s14 offen offset:2048 sc1
    s_mov_b64 exec, s[38:39]
    buffer_load_dwordx4 v[60:63], v2, s[56:59], s14 offen offset:3072 sc1
    s_mov_b64 exec, -1
    s_waitcnt vmcnt(12)
    v_cmp_ne_u64 s[42:43], s[40:41], v[66:67]
    v_cmp_ne_u64 s[44:45], s[40:41], v[70:71]
    v_cmp_ne_u64 s[46:47], s[40:41], v[74:75]
    v_cmp_ne_u64 s[66:67], s[40:41], v[78:79]
    v_cmp_ne_u64 s[68:69], s[40:41], v[82:83]
    v_cmp_ne_u64 s[70:71], s[40:41], v[86:87]
    v_cmp_ne_u64 s[72:73], s[40:41], v[90:91]
    v_cmp_ne_u64 s[74:75], s[40:41], v[94:95]
    v_cmp_ne_u64 s[94:95], s[40:41], v[98:99]
    v_cmp_ne_u64 s[96:97], s[40:41], v[102:103]
    v_cmp_ne_u64 s[98:99], s[40:41], v[106:107]
    v_cmp_ne_u64 s[100:101], s[40:41], v[110:111]
    s_mov_b32 s101, 0
    s_or_b64 s[60:61], s[42:43], 0
    s_or_b64 s[60:61], s[44:45], s[60:61]
    s_or_b64 s[60:61], s[46:47], s[60:61]
    s_or_b64 s[60:61], s[66:67], s[60:61]
    s_or_b64 s[60:61], s[68:69], s[60:61]
    s_or_b64 s[60:61], s[70:71], s[60:61]
    s_or_b64 s[60:61], s[72:73], s[60:61]
    s_or_b64 s[60:61], s[74:75], s[60:61]
    s_or_b64 s[60:61], s[94:95], s[60:61]
    s_or_b64 s[60:61], s[96:97], s[60:61]
    s_or_b64 s[60:61], s[98:99], s[60:61]
    s_or_b64 s[60:61], s[100:101], s[60:61]
    s_cbranch_scc0 L_fin_d1
    s_mov_b64 exec, s[42:43]
    buffer_load_dwordx4 v[64:67], v2, s[56:59], s12 offen offset:0 sc1
    s_mov_b64 exec, s[44:45]
    buffer_load_dwordx4 v[68:71], v2, s[56:59], s12 offen offset:1024 sc1
    s_mov_b64 exec, s[46:47]
    buffer_load_dwordx4 v[72:75], v2, s[56:59], s12 offen offset:2048 sc1
    s_mov_b64 exec, s[66:67]
    buffer_load_dwordx4 v[76:79], v2, s[56:59], s12 offen offset:3072 sc1
    s_mov_b64 exec, s[68:69]
    buffer_load_dwordx4 v[80:83], v2, s[56:59], s13 offen offset:0 sc1
    s_mov_b64 exec, s[70:71]
    buffer_load_dwordx4 v[84:87], v2, s[56:59], s13 offen offset:1024 sc1
    s_mov_b64 exec, s[72:73]
    buffer_load_dwordx4 v[88:91], v2, s[56:59], s13 offen offset:2048 sc1
    s_mov_b64 exec, s[74:75]
    buffer_load_dwordx4 v[92:95], v2, s[56:59], s13 offen offset:3072 sc1
    s_mov_b64 exec, s[94:95]
    buffer_load_dwordx4 v[96:99], v2, s[56:59], s14 offen offset:0 sc1
    s_mov_b64 exec, s[96:97]
    buffer_load_dwordx4 v[100:103], v2, s[56:59], s14 offen offset:1024 sc1
    s_mov_b64 exec, s[98:99]
    buffer_load_dwordx4 v[104:107], v2, s[56:59], s14 offen offset:2048 sc1
    s_mov_b64 exec, s[100:101]
    buffer_load_dwordx4 v[108:111], v2, s[56:59], s14 offen offset:3072 sc1
    s_mov_b64 exec, -1
    s_sub_u32 s64, s64, 1
    s_cbranch_scc1 L_end
    s_branch L_f_poll3
L_fin_d0:
    v_add_f32 v160, v16, v20
    v_add_f32 v164, v24, v28
    v_add_f32 v166, v32, v36
    v_add_f32 v168, v40, v44
    v_add_f32 v162, v48, v52
    v_add_f32 v170, v56, v60
    v_add_f32 v161, v17, v21
    v_add_f32 v165, v25, v29
    v_add_f32 v167, v33, v37
    v_add_f32 v169, v41, v45
    v_add_f32 v163, v49, v53
    v_add_f32 v171, v57, v61
    s_branch L_fin_dd
L_fin_d1:
    v_add_f32 v160, v64, v68
    v_add_f32 v164, v72, v76
    v_add_f32 v166, v80, v84
    v_add_f32 v168, v88, v92
    v_add_f32 v162, v96, v100
    v_add_f32 v170, v104, v108
    v_add_f32 v161, v65, v69
    v_add_f32 v165, v73, v77
    v_add_f32 v167, v81, v85
    v_add_f32 v169, v89, v93
    v_add_f32 v163, v97, v101
    v_add_f32 v171, v105, v109
L_fin_dd:
    v_add_f32 v160, v160, v164
    v_add_f32 v161, v161, v165
    v_add_f32 v166, v166, v168
    v_add_f32 v167, v167, v169
    v_add_f32 v162, v162, v170
    v_add_f32 v163, v163, v171
    v_add_f32 v160, v160, v166
    v_add_f32 v161, v161, v167
    s_nop 0
    v_add_f32_dpp v162, v162, v162 row_ror:4 row_mask:0xf bank_mask:0xf
    v_add_f32_dpp v163, v163, v163 row_ror:4 row_mask:0xf bank_mask:0xf
    v_add_f32_dpp v160, v160, v160 row_ror:4 row_mask:0xf bank_mask:0xf
    v_add_f32_dpp v161, v161, v161 row_ror:4 row_mask:0xf bank_mask:0xf
    s_nop 0
    v_add_f32_dpp v162, v162, v162 row_ror:8 row_mask:0xf bank_mask:0xf
    v_add_f32_dpp v163, v163, v163 row_ror:8 row_mask:0xf bank_mask:0xf
    v_add_f32_dpp v160, v160, v160 row_ror:8 row_mask:0xf bank_mask:0xf
    v_add_f32_dpp v161, v161, v161 row_ror:8 row_mask:0xf bank_mask:0xf
    v_mov_b32 v164, v160
    v_mov_b32 v165, v161
    v_mov_b32 v166, v162
    v_mov_b32 v167, v163
    s_nop 0
    v_permlane16_swap_b32 v160, v164
    v_permlane16_swap_b32 v161, v165
    v_permlane16_swap_b32 v162, v166
    v_permlane16_swap_b32 v163, v167
    v_add_f32 v160, v160, v164
    v_add_f32 v161, v161, v165
    v_add_f32 v162, v162, v166
    v_add_f32 v163, v163, v167
    v_mov_b32 v164, v160
    v_mov_b32 v165, v161
    v_mov_b32 v166, v162
    v_mov_b32 v167, v163
    s_nop 0
    v_permlane32_swap_b32 v160, v164
    v_permlane32_swap_b32 v161, v165
    v_permlane32_swap_b32 v162, v166
    v_permlane32_swap_b32 v163, v167
    v_add_f32 v160, v160, v164
    v_add_f32 v161, v161, v165
    v_add_f32 v162, v162, v166
    v_add_f32 v163, v163, v167
    v_cvt_pk_bf16_f32 v164, v160, v161
    v_cvt_pk_bf16_f32 v165, v162, v163
    v_lshlrev_b32 v160, 16, v164
    v_and_b32 v161, 0xffff0000, v164
    v_lshlrev_b32 v162, 16, v165
    v_and_b32 v163, 0xffff0000, v165
    v_mul_f32 v164, 0xbfb8aa3b, v162
    v_mul_f32 v165, 0xbfb8aa3b, v163
    v_exp_f32 v164, v164
    v_exp_f32 v165, v165
    s_nop 0
    v_add_f32 v164, 1.0, v164
    v_add_f32 v165, 1.0, v165
    v_rcp_f32 v166, v164
    v_rcp_f32 v167, v165
    s_nop 0
    v_mul_f32 v168, v162, v166
    v_mul_f32 v169, v163, v167
    v_fma_f32 v170, -v168, v164, v162
    v_fma_f32 v171, -v169, v165, v163
    v_fma_f32 v170, v170, v166, v168
    v_fma_f32 v171, v171, v167, v169
    v_cmp_class_f32 vcc, v170, 3
    v_cmp_class_f32 s[60:61], v171, 3
    s_nop 1
    v_cndmask_b32 v170, v170, v168, vcc
    v_cndmask_b32_e64 v171, v171, v169, s[60:61]
    v_cvt_pk_bf16_f32 v164, v170, v171
    v_lshlrev_b32 v170, 16, v164
    v_and_b32 v171, 0xffff0000, v164
    v_mul_f32 v170, v160, v170
    v_mul_f32 v171, v161, v171
    v_cvt_pk_bf16_f32 v164, v170, v171
    v_lshlrev_b32 v170, 16, v164
    v_and_b32 v171, 0xffff0000, v164
    v_lshlrev_b32 v164, 16, v6
    v_and_b32 v165, 0xffff0000, v6
    v_add_f32 v170, v164, v170
    v_add_f32 v171, v165, v171
    v_cvt_pk_bf16_f32 v164, v170, v171
    s_mov_b64 exec, 15
    buffer_store_dword v164, v3, s[52:55], 0 offen sc1
    s_cmp_lg_u32 s65, 0
    s_cbranch_scc1 L_q_done
    s_mov_b64 exec, 1
    v_mov_b32 v166, s40
    v_mov_b32 v167, s41
    v_mov_b32 v168, 0
    buffer_store_dwordx2 v[166:167], v168, s[56:59], 0 offen sc1
L_q_done:
    s_endpgm
.p2align 12
L_att_x:
    s_mov_b64 exec, -1
L_att:
    s_sub_u32 s62, s3, 2
    s_lshl_b32 s6, s62, 13
    s_add_u32 s6, s6, 16384
    v_lshlrev_b32 v2, 8, v4
    v_add_u32 v2, s6, v2
    v_add_u32 v3, 0, v5
    v_xor_b32 v3, v3, v4
    v_lshl_add_u32 v8, v3, 4, v2
    v_add_u32 v3, 4, v5
    v_xor_b32 v3, v3, v4
    v_lshl_add_u32 v9, v3, 4, v2
    v_add_u32 v3, 8, v5
    v_xor_b32 v3, v3, v4
    v_lshl_add_u32 v10, v3, 4, v2
    v_add_u32 v3, 12, v5
    v_xor_b32 v3, v3, v4
    v_lshl_add_u32 v11, v3, 4, v2
    v_lshrrev_b32 v3, 2, v4
    v_lshlrev_b32 v6, 8, v3
    v_lshl_or_b32 v6, v5, 4, v6
    v_add_u32 v6, 123904, v6
    v_lshl_add_u32 v2, v5, 2, v3
    v_lshlrev_b32 v2, 8, v2
    v_add_u32 v2, 49152, v2
    v_and_b32 v12, 1, v0
    v_lshl_add_u32 v2, v12, 3, v2
    v_and_b32 v12, 1, v5
    v_lshl_add_u32 v12, v12, 2, v3
    v_lshlrev_b32 v12, 1, v12
    v_bfe_u32 v13, v0, 1, 1
    s_lshl_b32 s6, s62, 2
    v_add_u32 v13, s6, v13
    v_xor_b32 v12, v12, v13
    v_lshl_add_u32 v12, v12, 4, v2
    v_xor_b32 v13, 32, v12
    v_lshlrev_b32 v15, 4, v0
    v_add_u32 v15, 124928, v15
    s_lshl_b32 s6, s62, 10
    v_add_u32 v14, s6, v15
    v_lshlrev_b32 v17, 4, v3
    v_add_u32 v17, 131072, v17
    s_lshl_b32 s6, s62, 6
    v_add_u32 v16, s6, v17
    s_lshl_b32 s6, s4, 17
    s_lshl_b32 s7, s62, 13
    s_add_u32 s6, s6, s7
    s_lshl_b32 s7, s5, 8
    s_add_u32 s6, s6, s7
    s_add_u32 s12, s6, 0x100000
    v_lshlrev_b32 v18, 15, v3
    v_lshl_or_b32 v18, v5, 6, v18
    v_and_b32 v2, 3, v0
    v_lshl_or_b32 v18, v2, 4, v18
    s_lshl_b32 s6, s4, 11
    s_lshl_b32 s7, s5, 4
    s_add_u32 s6, s6, s7
    s_add_u32 s13, s6, 0x1000
    v_lshlrev_b32 v19, 9, v3
    s_mov_b32 s8, 0xaaaaaaaa
    s_mov_b32 s9, 0xaaaaaaaa
    s_mov_b32 s10, 0xcccccccc
    s_mov_b32 s11, 0xcccccccc
    s_mov_b32 s14, 0x3db504f3
    s_mov_b32 s15, 0x3fb8aa3b
    s_lshl_b32 s63, s62, 3
    s_add_u32 s63, s63, 24
    s_cmp_lg_u32 s62, 0
    s_cbranch_scc1 L_att_gt
    s_waitcnt lgkmcnt(0)
    s_add_u32 s40, s40, 16
    s_and_b32 s40, s40, -16
    s_add_u32 s41, s41, 0x9e3779b9
    v_mov_b32 v22, s40
    v_mov_b32 v23, s41
    v_mov_b32 v24, 1
    ds_write_b96 v7, v[22:24] offset:16
    s_branch L_att_nt
L_att_gt:
    s_mov_b32 s64, SPIN
L_gt_5:
    ds_read_b96 v[22:24], v7 offset:16
    s_waitcnt lgkmcnt(0)
    v_cmp_eq_u32 vcc, 0, v24
    s_cbranch_vccz L_gt_5_ok
    s_sleep 10
    s_sub_u32 s64, s64, 1
    s_cbranch_scc1 L_end
    s_branch L_gt_5
L_gt_5_ok:
    v_readfirstlane_b32 s40, v22
    v_readfirstlane_b32 s41, v23
    s_nop 1
L_att_nt:
    s_lshl_b32 s16, s4, 14
    s_lshl_b32 s6, s62, 10
    s_add_u32 s16, s16, s6
    s_add_u32 s16, s16, 0x200000
    s_add_u32 s17, s16, 0x1000
    s_add_u32 s18, s16, 0x2000
    s_add_u32 s19, s16, 0x3000
    v_lshlrev_b32 v21, 4, v0
    s_lshl_b32 s6, s62, 8
    s_add_u32 s6, s6, 123904
    v_lshlrev_b32 v25, 2, v0
    v_add_u32 v25, s6, v25
    s_or_b32 s46, s40, s44
    s_mov_b32 s47, s41
    s_mov_b32 s65, 0
    s_mov_b64 s[20:21], -1
    s_mov_b64 s[22:23], -1
    s_mov_b64 s[24:25], -1
    s_mov_b64 s[26:27], -1
    s_mov_b64 s[28:29], -1
    s_mov_b64 s[30:31], -1
    s_mov_b64 s[32:33], -1
    s_mov_b64 s[34:35], -1
    s_mov_b32 s64, SPIN
L_w_6:
    ds_read_b32 v20, v7 offset:36
    s_waitcnt lgkmcnt(0)
    v_cmp_gt_u32 vcc, 1, v20
    s_cbranch_vccz L_w_6_ok
    s_sleep 2
    s_sub_u32 s64, s64, 1
    s_cbranch_scc1 L_end
    s_branch L_w_6
L_w_6_ok:
    s_setprio 2
    s_sleep 22
    s_mov_b64 exec, s[20:21]
    buffer_load_dwordx4 v[128:131], v21, s[56:59], s16 offen sc1
    s_mov_b64 exec, s[22:23]
    buffer_load_dwordx4 v[132:135], v21, s[56:59], s17 offen sc1
    s_mov_b64 exec, s[24:25]
    buffer_load_dwordx4 v[136:139], v21, s[56:59], s18 offen sc1
    s_mov_b64 exec, s[26:27]
    buffer_load_dwordx4 v[140:143], v21, s[56:59], s19 offen sc1
    s_mov_b64 exec, -1
    s_mov_b32 s64, 16
L_q_poll:
    s_cmp_lg_u32 s65, 0
    s_cbranch_scc1 L_q_nk
    ds_read_b32 v20, v7 offset:0
    s_waitcnt lgkmcnt(0)
    v_cmp_gt_u32 vcc, s63, v20
    s_cbranch_vccnz L_q_nk
    ds_read_b128 v[32:35], v8 offset:0
    ds_read_b128 v[36:39], v9 offset:0
    ds_read_b128 v[40:43], v10 offset:0
    ds_read_b128 v[44:47], v11 offset:0
    ds_read_b128 v[48:51], v8 offset:4096
    ds_read_b128 v[52:55], v9 offset:4096
    ds_read_b128 v[56:59], v10 offset:4096
    ds_read_b128 v[60:63], v11 offset:4096
    s_mov_b32 s65, 1
L_q_nk:
    s_waitcnt vmcnt(0)
    v_cmp_ne_u64 s[20:21], s[46:47], v[130:131]
    v_cmp_ne_u64 s[22:23], s[46:47], v[134:135]
    v_cmp_ne_u64 s[24:25], s[46:47], v[138:139]
    v_cmp_ne_u64 s[26:27], s[46:47], v[142:143]
    s_or_b64 s[60:61], s[20:21], 0
    s_or_b64 s[60:61], s[22:23], s[60:61]
    s_or_b64 s[60:61], s[24:25], s[60:61]
    s_or_b64 s[60:61], s[26:27], s[60:61]
    s_cbranch_scc0 L_q_d0
    s_mov_b64 exec, s[20:21]
    buffer_load_dwordx4 v[128:131], v21, s[56:59], s16 offen sc1
    s_mov_b64 exec, s[22:23]
    buffer_load_dwordx4 v[132:135], v21, s[56:59], s17 offen sc1
    s_mov_b64 exec, s[24:25]
    buffer_load_dwordx4 v[136:139], v21, s[56:59], s18 offen sc1
    s_mov_b64 exec, s[26:27]
    buffer_load_dwordx4 v[140:143], v21, s[56:59], s19 offen sc1
    s_mov_b64 exec, -1
    s_sub_u32 s64, s64, 1
    s_cbranch_scc0 L_q_poll
    s_branch L_a_slow
L_q_d1:
    v_add_f32 v26, v144, v148
    v_add_f32 v27, v145, v149
    v_add_f32 v28, v152, v156
    v_add_f32 v29, v153, v157
    s_branch L_q_d
L_q_d0:
    v_add_f32 v26, v128, v132
    v_add_f32 v27, v129, v133
    v_add_f32 v28, v136, v140
    v_add_f32 v29, v137, v141
L_q_d:
    v_add_f32 v26, v26, v28
    v_add_f32 v27, v27, v29
    v_cvt_pk_bf16_f32 v26, v26, v27
    ds_write_b32 v25, v26
    s_mov_b64 exec, 1
    ds_add_u32 v7, v24 offset:8
    s_mov_b64 exec, -1
    s_cmp_lg_u32 s65, 0
    s_cbranch_scc1 L_att_kok
    s_mov_b32 s64, SPIN
L_att_kw:
    ds_read_b32 v20, v7 offset:0
    s_waitcnt lgkmcnt(0)
    v_cmp_gt_u32 vcc, s63, v20
    s_cbranch_vccz L_att_kgo
    s_sleep 1
    s_sub_u32 s64, s64, 1
    s_cbranch_scc1 L_end
    s_branch L_att_kw
L_att_kgo:
    ds_read_b128 v[32:35], v8 offset:0
    ds_read_b128 v[36:39], v9 offset:0
    ds_read_b128 v[40:43], v10 offset:0
    ds_read_b128 v[44:47], v11 offset:0
    ds_read_b128 v[48:51], v8 offset:4096
    ds_read_b128 v[52:55], v9 offset:4096
    ds_read_b128 v[56:59], v10 offset:4096
    ds_read_b128 v[60:63], v11 offset:4096
L_att_kok:
    s_mov_b32 s64, SPIN
L_att_qw:
    ds_read_b96 v[28:30], v7 offset:0
    ds_read_b128 v[64:67], v6 offset:0
    ds_read_b128 v[68:71], v6 offset:64
    ds_read_b128 v[72:75], v6 offset:128
    ds_read_b128 v[76:79], v6 offset:192
    s_waitcnt lgkmcnt(0)
    v_and_b32 v26, 7, v30
    v_cmp_ne_u32 vcc, 4, v26
    s_cbranch_vccz L_att_qok
    s_sub_u32 s64, s64, 1
    s_cbranch_scc1 L_end
    s_branch L_att_qw
L_att_qok:
    s_setprio 3
    v_readfirstlane_b32 s45, v30
    v_cmp_gt_u32 vcc, 0x50, v28
    v_mfma_f32_16x16x32_bf16 v[80:83], v[32:35], v[64:67], 0
    v_mfma_f32_16x16x32_bf16 v[84:87], v[48:51], v[64:67], 0
    v_mfma_f32_16x16x32_bf16 v[80:83], v[36:39], v[68:71], v[80:83]
    v_mfma_f32_16x16x32_bf16 v[84:87], v[52:55], v[68:71], v[84:87]
    v_mfma_f32_16x16x32_bf16 v[80:83], v[40:43], v[72:75], v[80:83]
    v_mfma_f32_16x16x32_bf16 v[84:87], v[56:59], v[72:75], v[84:87]
    v_mfma_f32_16x16x32_bf16 v[80:83], v[44:47], v[76:79], v[80:83]
    v_mfma_f32_16x16x32_bf16 v[84:87], v[60:63], v[76:79], v[84:87]
    s_cbranch_vccnz L_att_nv1
    ds_read_b64_tr_b16 v[96:97], v12 offset:0
    ds_read_b64_tr_b16 v[98:99], v12 offset:4096
    ds_read_b64_tr_b16 v[100:101], v13 offset:0
    ds_read_b64_tr_b16 v[102:103], v13 offset:4096
    ds_read_b64_tr_b16 v[104:105], v12 offset:8192
    ds_read_b64_tr_b16 v[106:107], v12 offset:12288
    ds_read_b64_tr_b16 v[108:109], v13 offset:8192
    ds_read_b64_tr_b16 v[110:111], v13 offset:12288
    ds_read_b64_tr_b16 v[112:113], v12 offset:16384
    ds_read_b64_tr_b16 v[114:115], v12 offset:20480
    ds_read_b64_tr_b16 v[116:117], v13 offset:16384
    ds_read_b64_tr_b16 v[118:119], v13 offset:20480
    ds_read_b64_tr_b16 v[120:121], v12 offset:24576
    ds_read_b64_tr_b16 v[122:123], v12 offset:28672
    ds_read_b64_tr_b16 v[124:125], v13 offset:24576
    ds_read_b64_tr_b16 v[126:127], v13 offset:28672
    s_mov_b32 s65, 2
L_att_nv1:
    s_nop 7
    v_cvt_pk_bf16_f32 v80, 0, v80
    v_cvt_pk_bf16_f32 v81, 0, v81
    v_cvt_pk_bf16_f32 v82, 0, v82
    v_cvt_pk_bf16_f32 v83, 0, v83
    v_cvt_pk_bf16_f32 v84, 0, v84
    v_cvt_pk_bf16_f32 v85, 0, v85
    v_cvt_pk_bf16_f32 v86, 0, v86
    v_cvt_pk_bf16_f32 v87, 0, v87
    v_mul_f32 v80, s14, v80
    v_mul_f32 v81, s14, v81
    v_mul_f32 v82, s14, v82
    v_mul_f32 v83, s14, v83
    v_mul_f32 v84, s14, v84
    v_mul_f32 v85, s14, v85
    v_mul_f32 v86, s14, v86
    v_mul_f32 v87, s14, v87
    v_cvt_pk_bf16_f32 v80, 0, v80
    v_cvt_pk_bf16_f32 v81, 0, v81
    v_cvt_pk_bf16_f32 v82, 0, v82
    v_cvt_pk_bf16_f32 v83, 0, v83
    v_cvt_pk_bf16_f32 v84, 0, v84
    v_cvt_pk_bf16_f32 v85, 0, v85
    v_cvt_pk_bf16_f32 v86, 0, v86
    v_cvt_pk_bf16_f32 v87, 0, v87
    v_max3_f32 v92, v80, v81, v82
    v_max3_f32 v93, v83, v84, v85
    v_max3_f32 v92, v92, v86, v87
    v_max_f32 v92, v92, v93
    v_mov_b32 v93, v92
    s_nop 1
    v_permlane16_swap_b32 v92, v93
    v_max_f32 v92, v92, v93
    v_mov_b32 v93, v92
    s_nop 1
    v_permlane32_swap_b32 v92, v93
    v_max_f32 v92, v92, v93
    v_mul_f32 v92, s15, v92
    v_fma_f32 v80, v80, s15, -v92
    v_fma_f32 v81, v81, s15, -v92
    v_fma_f32 v82, v82, s15, -v92
    v_fma_f32 v83, v83, s15, -v92
    v_fma_f32 v84, v84, s15, -v92
    v_fma_f32 v85, v85, s15, -v92
    v_fma_f32 v86, v86, s15, -v92
    v_fma_f32 v87, v87, s15, -v92
    v_exp_f32 v80, v80
    v_exp_f32 v81, v81
    v_exp_f32 v82, v82
    v_exp_f32 v83, v83
    v_exp_f32 v84, v84
    v_exp_f32 v85, v85
    v_exp_f32 v86, v86
    v_exp_f32 v87, v87
    s_nop 0
    v_cvt_pk_bf16_f32 v88, v80, v81
    v_cvt_pk_bf16_f32 v89, v82, v83
    v_cvt_pk_bf16_f32 v90, v84, v85
    v_cvt_pk_bf16_f32 v91, v86, v87
    ds_write_b128 v14, v[88:91]
    v_add_f32 v93, v80, v81
    v_add_f32 v94, v82, v83
    v_add_f32 v95, v84, v85
    v_add_f32 v31, v86, v87
    v_add_f32 v93, v93, v94
    v_add_f32 v95, v95, v31
    v_add_f32 v93, v93, v95
    v_mov_b32 v31, v93
    s_nop 1
    v_permlane16_swap_b32 v93, v31
    v_add_f32 v93, v93, v31
    v_mov_b32 v31, v93
    s_nop 1
    v_permlane32_swap_b32 v93, v31
    v_add_f32 v93, v93, v31
    v_mov_b32 v94, 1
    v_mov_b32 v95, 1
    s_mov_b64 exec, 0x1111
    ds_write_b128 v16, v[92:95]
    s_mov_b64 exec, -1
    s_cmp_eq_u32 s65, 2
    s_cbranch_scc1 L_att_nv2
    ds_read_b32 v28, v7 offset:0
    s_waitcnt lgkmcnt(0)
    v_cmp_gt_u32 vcc, 0x50, v28
    s_cbranch_vccnz L_att_nv2
    ds_read_b64_tr_b16 v[96:97], v12 offset:0
    ds_read_b64_tr_b16 v[98:99], v12 offset:4096
    ds_read_b64_tr_b16 v[100:101], v13 offset:0
    ds_read_b64_tr_b16 v[102:103], v13 offset:4096
    ds_read_b64_tr_b16 v[104:105], v12 offset:8192
    ds_read_b64_tr_b16 v[106:107], v12 offset:12288
    ds_read_b64_tr_b16 v[108:109], v13 offset:8192
    ds_read_b64_tr_b16 v[110:111], v13 offset:12288
    ds_read_b64_tr_b16 v[112:113], v12 offset:16384
    ds_read_b64_tr_b16 v[114:115], v12 offset:20480
    ds_read_b64_tr_b16 v[116:117], v13 offset:16384
    ds_read_b64_tr_b16 v[118:119], v13 offset:20480
    ds_read_b64_tr_b16 v[120:121], v12 offset:24576
    ds_read_b64_tr_b16 v[122:123], v12 offset:28672
    ds_read_b64_tr_b16 v[124:125], v13 offset:24576
    ds_read_b64_tr_b16 v[126:127], v13 offset:28672
    s_mov_b32 s65, 2
L_att_nv2:
    s_mov_b32 s64, SPIN
L_att_pw:
    s_sub_u32 s64, s64, 1
    s_cbranch_scc1 L_end
    ds_read_b128 v[32:35], v17 offset:0
    ds_read_b128 v[36:39], v17 offset:64
    ds_read_b128 v[40:43], v17 offset:128
    ds_read_b128 v[44:47], v17 offset:192
    ds_read_b128 v[48:51], v15 offset:0
    ds_read_b128 v[52:55], v15 offset:1024
    ds_read_b128 v[56:59], v15 offset:2048
    ds_read_b128 v[60:63], v15 offset:3072
    s_waitcnt lgkmcnt(0)
    v_min_u32 v64, v34, v38
    v_min3_u32 v64, v64, v42, v46
    v_cmp_eq_u32 vcc, 0, v64
    s_cbranch_vccnz L_att_pw
    s_cmp_lg_u32 s65, 2
    s_cbranch_scc1 L_att_nv3
    v_mfma_f32_16x16x32_bf16 v[160:163], v[96:99], v[48:51], 0
    v_mfma_f32_16x16x32_bf16 v[164:167], v[100:103], v[48:51], 0
    v_mfma_f32_16x16x32_bf16 v[168:171], v[104:107], v[52:55], 0
    v_mfma_f32_16x16x32_bf16 v[172:175], v[108:111], v[52:55], 0
    v_mfma_f32_16x16x32_bf16 v[176:179], v[112:115], v[56:59], 0
    v_mfma_f32_16x16x32_bf16 v[180:183], v[116:119], v[56:59], 0
    v_mfma_f32_16x16x32_bf16 v[184:187], v[120:123], v[60:63], 0
    v_mfma_f32_16x16x32_bf16 v[188:191], v[124:127], v[60:63], 0
L_att_nv3:
    v_max3_f32 v64, v32, v36, v40
    v_max_f32 v64, v64, v44
    v_sub_f32 v68, v32, v64
    v_sub_f32 v69, v36, v64
    v_sub_f32 v70, v40, v64
    v_sub_f32 v71, v44, v64
    v_exp_f32 v68, v68
    v_exp_f32 v69, v69
    v_exp_f32 v70, v70
    v_exp_f32 v71, v71
    s_nop 0
    v_mul_f32 v65, v68, v33
    v_fmac_f32 v65, v69, v37
    v_fmac_f32 v65, v70, v41
    v_fmac_f32 v65, v71, v45
    v_mov_b32 v66, v22
    v_mov_b32 v67, v23
    v_mov_b32 v74, v22
    v_mov_b32 v75, v23
    s_cmp_lg_u32 s62, 0
    s_cbranch_scc1 L_att_nost
    s_mov_b64 exec, 0x1111
    s_cmp_eq_u32 s45, 4
    s_cbranch_scc1 L_att_stf
    buffer_store_dwordx4 v[64:67], v19, s[56:59], s13 offen sc1
    s_branch L_att_st2
L_att_stf:
    buffer_store_dwordx4 v[64:67], v19, s[56:59], s13 offen
L_att_st2:
    s_mov_b64 exec, -1
    ds_write_b32 v7, v34 offset:28
L_att_nost:
PAD_A1:
    s_cbranch_execz L_att_x
    s_cmp_lg_u32 s65, 2
    s_cbranch_scc1 L_att_nv4
    v_cndmask_b32_e64 v160, v160, v162, s[8:9]
    v_cndmask_b32_e64 v161, v161, v163, s[8:9]
    v_cndmask_b32_e64 v164, v164, v166, s[8:9]
    v_cndmask_b32_e64 v165, v165, v167, s[8:9]
    v_cndmask_b32_e64 v160, v160, v164, s[10:11]
    v_cndmask_b32_e64 v161, v161, v165, s[10:11]
    v_mul_f32 v72, v68, v160
    v_mul_f32 v73, v68, v161
    v_cndmask_b32_e64 v168, v168, v170, s[8:9]
    v_cndmask_b32_e64 v169, v169, v171, s[8:9]
    v_cndmask_b32_e64 v172, v172, v174, s[8:9]
    v_cndmask_b32_e64 v173, v173, v175, s[8:9]
    v_cndmask_b32_e64 v168, v168, v172, s[10:11]
    v_cndmask_b32_e64 v169, v169, v173, s[10:11]
    v_fmac_f32 v72, v69, v168
    v_fmac_f32 v73, v69, v169
    v_cndmask_b32_e64 v176, v176, v178, s[8:9]
    v_cndmask_b32_e64 v177, v177, v179, s[8:9]
    v_cndmask_b32_e64 v180, v180, v182, s[8:9]
    v_cndmask_b32_e64 v181, v181, v183, s[8:9]
    v_cndmask_b32_e64 v176, v176, v180, s[10:11]
    v_cndmask_b32_e64 v177, v177, v181, s[10:11]
    v_fmac_f32 v72, v70, v176
    v_fmac_f32 v73, v70, v177
    s_branch L_att_pv3
L_att_nv4:
    s_mov_b32 s64, SPIN
L_w_7:
    ds_read_b32 v76, v7 offset:0
    s_waitcnt lgkmcnt(0)
    v_cmp_gt_u32 vcc, 0x48, v76
    s_cbranch_vccz L_w_7_ok
    s_sleep 1
    s_sub_u32 s64, s64, 1
    s_cbranch_scc1 L_end
    s_branch L_w_7
L_w_7_ok:
    ds_read_b64_tr_b16 v[96:97], v12 offset:0
    ds_read_b64_tr_b16 v[98:99], v12 offset:4096
    ds_read_b64_tr_b16 v[100:101], v13 offset:0
    ds_read_b64_tr_b16 v[102:103], v13 offset:4096
    ds_read_b64_tr_b16 v[104:105], v12 offset:8192
    ds_read_b64_tr_b16 v[106:107], v12 offset:12288
    ds_read_b64_tr_b16 v[108:109], v13 offset:8192
    ds_read_b64_tr_b16 v[110:111], v13 offset:12288
    ds_read_b64_tr_b16 v[112:113], v12 offset:16384
    ds_read_b64_tr_b16 v[114:115], v12 offset:20480
    ds_read_b64_tr_b16 v[116:117], v13 offset:16384
    ds_read_b64_tr_b16 v[118:119], v13 offset:20480
    ds_read_b32 v76, v7 offset:0
    s_waitcnt lgkmcnt(11)
    v_mfma_f32_16x16x32_bf16 v[160:163], v[96:99], v[48:51], 0
    s_waitcnt lgkmcnt(9)
    v_mfma_f32_16x16x32_bf16 v[164:167], v[100:103], v[48:51], 0
    s_waitcnt lgkmcnt(7)
    v_mfma_f32_16x16x32_bf16 v[168:171], v[104:107], v[52:55], 0
    s_waitcnt lgkmcnt(5)
    v_mfma_f32_16x16x32_bf16 v[172:175], v[108:111], v[52:55], 0
    s_waitcnt lgkmcnt(3)
    v_mfma_f32_16x16x32_bf16 v[176:179], v[112:115], v[56:59], 0
    s_waitcnt lgkmcnt(1)
    v_mfma_f32_16x16x32_bf16 v[180:183], v[116:119], v[56:59], 0
    s_waitcnt lgkmcnt(0)
    v_cmp_gt_u32 vcc, 0x50, v76
    s_cbranch_vccnz L_att_pvs
    ds_read_b64_tr_b16 v[120:121], v12 offset:24576
    ds_read_b64_tr_b16 v[122:123], v12 offset:28672
    ds_read_b64_tr_b16 v[124:125], v13 offset:24576
    ds_read_b64_tr_b16 v[126:127], v13 offset:28672
    v_cndmask_b32_e64 v160, v160, v162, s[8:9]
    v_cndmask_b32_e64 v161, v161, v163, s[8:9]
    v_cndmask_b32_e64 v164, v164, v166, s[8:9]
    v_cndmask_b32_e64 v165, v165, v167, s[8:9]
    v_cndmask_b32_e64 v160, v160, v164, s[10:11]
    v_cndmask_b32_e64 v161, v161, v165, s[10:11]
    v_mul_f32 v72, v68, v160
    v_mul_f32 v73, v68, v161
    v_cndmask_b32_e64 v168, v168, v170, s[8:9]
    v_cndmask_b32_e64 v169, v169, v171, s[8:9]
    v_cndmask_b32_e64 v172, v172, v174, s[8:9]
    v_cndmask_b32_e64 v173, v173, v175, s[8:9]
    v_cndmask_b32_e64 v168, v168, v172, s[10:11]
    v_cndmask_b32_e64 v169, v169, v173, s[10:11]
    v_fmac_f32 v72, v69, v168
    v_fmac_f32 v73, v69, v169
    s_waitcnt lgkmcnt(2)
    v_mfma_f32_16x16x32_bf16 v[184:187], v[120:123], v[60:63], 0
    s_waitcnt lgkmcnt(0)
    v_mfma_f32_16x16x32_bf16 v[188:191], v[124:127], v[60:63], 0
    v_cndmask_b32_e64 v176, v176, v178, s[8:9]
    v_cndmask_b32_e64 v177, v177, v179, s[8:9]
    v_cndmask_b32_e64 v180, v180, v182, s[8:9]
    v_cndmask_b32_e64 v181, v181, v183, s[8:9]
    v_cndmask_b32_e64 v176, v176, v180, s[10:11]
    v_cndmask_b32_e64 v177, v177, v181, s[10:11]
    v_fmac_f32 v72, v70, v176
    v_fmac_f32 v73, v70, v177
    s_branch L_att_pv3
L_att_pvs:
    s_nop 3
    v_cndmask_b32_e64 v160, v160, v162, s[8:9]
    v_cndmask_b32_e64 v161, v161, v163, s[8:9]
    v_cndmask_b32_e64 v164, v164, v166, s[8:9]
    v_cndmask_b32_e64 v165, v165, v167, s[8:9]
    v_cndmask_b32_e64 v160, v160, v164, s[10:11]
    v_cndmask_b32_e64 v161, v161, v165, s[10:11]
    v_mul_f32 v72, v68, v160
    v_mul_f32 v73, v68, v161
    v_cndmask_b32_e64 v168, v168, v170, s[8:9]
    v_cndmask_b32_e64 v169, v169, v171, s[8:9]
    v_cndmask_b32_e64 v172, v172, v174, s[8:9]
    v_cndmask_b32_e64 v173, v173, v175, s[8:9]
    v_cndmask_b32_e64 v168, v168, v172, s[10:11]
    v_cndmask_b32_e64 v169, v169, v173, s[10:11]
    v_fmac_f32 v72, v69, v168
    v_fmac_f32 v73, v69, v169
    v_cndmask_b32_e64 v176, v176, v178, s[8:9]
    v_cndmask_b32_e64 v177, v177, v179, s[8:9]
    v_cndmask_b32_e64 v180, v180, v182, s[8:9]
    v_cndmask_b32_e64 v181, v181, v183, s[8:9]
    v_cndmask_b32_e64 v176, v176, v180, s[10:11]
    v_cndmask_b32_e64 v177, v177, v181, s[10:11]
    v_fmac_f32 v72, v70, v176
    v_fmac_f32 v73, v70, v177
    s_mov_b32 s64, SPIN
L_w_8:
    ds_read_b32 v76, v7 offset:0
    s_waitcnt lgkmcnt(0)
    v_cmp_gt_u32 vcc, 0x50, v76
    s_cbranch_vccz L_w_8_ok
    s_sub_u32 s64, s64, 1
    s_cbranch_scc1 L_end
    s_branch L_w_8
L_w_8_ok:
    ds_read_b64_tr_b16 v[120:121], v12 offset:24576
    ds_read_b64_tr_b16 v[122:123], v12 offset:28672
    ds_read_b64_tr_b16 v[124:125], v13 offset:24576
    ds_read_b64_tr_b16 v[126:127], v13 offset:28672
    s_waitcnt lgkmcnt(2)
    v_mfma_f32_16x16x32_bf16 v[184:187], v[120:123], v[60:63], 0
    s_waitcnt lgkmcnt(0)
    v_mfma_f32_16x16x32_bf16 v[188:191], v[124:127], v[60:63], 0
    s_nop 7
L_att_pv3:
    s_nop 1
    v_cndmask_b32_e64 v184, v184, v186, s[8:9]
    v_cndmask_b32_e64 v185, v185, v187, s[8:9]
    v_cndmask_b32_e64 v188, v188, v190, s[8:9]
    v_cndmask_b32_e64 v189, v189, v191, s[8:9]
    v_cndmask_b32_e64 v184, v184, v188, s[10:11]
    v_cndmask_b32_e64 v185, v185, v189, s[10:11]
    v_fmac_f32 v72, v71, v184
    v_fmac_f32 v73, v71, v185
    s_cmp_eq_u32 s45, 4
    s_cbranch_scc1 L_att_of
    buffer_store_dwordx4 v[72:75], v18, s[56:59], s12 offen sc1
    s_branch L_att_o2
L_att_of:
    buffer_store_dwordx4 v[72:75], v18, s[56:59], s12 offen
L_att_o2:
    s_endpgm
L_a_slow:
    ds_write_b32 v7, v24 offset:12
    v_mov_b32 v24, 0x101
    s_waitcnt vmcnt(0)
    s_mov_b32 s64, 0
    s_mov_b64 s[20:21], -1
    s_mov_b64 s[22:23], -1
    s_mov_b64 s[24:25], -1
    s_mov_b64 s[26:27], -1
L_a_spoll:
    s_mov_b32 s6, 0
    s_bitcmp1_b32 s64, 0
    s_cselect_b32 s6, 0, 0x20000
    s_add_u32 s28, s16, s6
    s_add_u32 s29, s17, s6
    s_add_u32 s30, s18, s6
    s_add_u32 s31, s19, s6
    s_mov_b64 exec, s[20:21]
    buffer_load_dwordx4 v[128:131], v21, s[56:59], s28 offen sc1
    s_mov_b64 exec, s[22:23]
    buffer_load_dwordx4 v[132:135], v21, s[56:59], s29 offen sc1
    s_mov_b64 exec, s[24:25]
    buffer_load_dwordx4 v[136:139], v21, s[56:59], s30 offen sc1
    s_mov_b64 exec, s[26:27]
    buffer_load_dwordx4 v[140:143], v21, s[56:59], s31 offen sc1
    s_mov_b64 exec, -1
    s_add_u32 s64, s64, 1
    s_cmp_gt_u32 s64, SPIN
    s_cbranch_scc1 L_end
    s_waitcnt vmcnt(0)
    v_xor_b32 v26, s40, v130
    v_cmp_lt_u32 s[20:21], 15, v26
    v_cmp_ne_u32 vcc, s41, v131
    s_or_b64 s[20:21], s[20:21], vcc
    s_or_b64 s[60:61], s[20:21], 0
    v_xor_b32 v26, s40, v134
    v_cmp_lt_u32 s[22:23], 15, v26
    v_cmp_ne_u32 vcc, s41, v135
    s_or_b64 s[22:23], s[22:23], vcc
    s_or_b64 s[60:61], s[22:23], s[60:61]
    v_xor_b32 v26, s40, v138
    v_cmp_lt_u32 s[24:25], 15, v26
    v_cmp_ne_u32 vcc, s41, v139
    s_or_b64 s[24:25], s[24:25], vcc
    s_or_b64 s[60:61], s[24:25], s[60:61]
    v_xor_b32 v26, s40, v142
    v_cmp_lt_u32 s[26:27], 15, v26
    v_cmp_ne_u32 vcc, s41, v143
    s_or_b64 s[26:27], s[26:27], vcc
    s_or_b64 s[60:61], s[26:27], s[60:61]
    s_cbranch_scc1 L_a_spoll
    s_branch L_q_d0
.p2align 12
L_o:
    s_lshl_b32 s10, s4, 11
    s_lshr_b32 s6, s5, 3
    s_lshl_b32 s6, s6, 9
    s_add_u32 s10, s10, s6
    s_add_u32 s10, s10, 0x1000
    v_lshlrev_b32 v8, 4, v5
    s_lshl_b32 s6, s4, 4
    s_lshr_b32 s7, s5, 1
    s_add_u32 s6, s6, s7
    s_lshl_b32 s11, s6, 13
    s_add_u32 s11, s11, 0x100000
    s_add_u32 s12, s11, 4096
    v_lshlrev_b32 v2, 4, v0
    v_bfe_u32 v3, v0, 1, 1
    v_lshlrev_b32 v9, 5, v3
    v_bfe_u32 v3, v0, 2, 2
    v_lshl_or_b32 v9, v3, 3, v9
    v_and_b32 v6, 1, v0
    v_lshl_or_b32 v9, v6, 2, v9
    v_add_u32 v9, 129472, v9
    v_lshrrev_b32 v10, 1, v4
    v_lshlrev_b32 v10, 6, v10
    v_lshl_or_b32 v10, v5, 4, v10
    v_add_u32 v10, 129024, v10
    v_lshl_add_u32 v6, v5, 3, v3
    v_lshlrev_b32 v6, 9, v6
    v_add_u32 v6, 98304, v6
    v_and_b32 v11, 3, v0
    v_xor_b32 v16, 0, v3
    v_lshl_or_b32 v16, v16, 2, v11
    v_lshl_add_u32 v12, v16, 4, v6
    v_xor_b32 v16, 1, v3
    v_lshl_or_b32 v16, v16, 2, v11
    v_lshl_add_u32 v13, v16, 4, v6
    v_xor_b32 v16, 2, v3
    v_lshl_or_b32 v16, v16, 2, v11
    v_lshl_add_u32 v14, v16, 4, v6
    v_xor_b32 v16, 3, v3
    v_lshl_or_b32 v16, v16, 2, v11
    v_lshl_add_u32 v15, v16, 4, v6
    s_lshl_b32 s6, s6, 6
    s_and_b32 s7, s5, 1
    s_lshl_b32 s7, s7, 18
    s_add_u32 s6, s6, s7
    s_add_u32 s14, s6, 0x80000
    s_add_u32 s15, s14, 0x20000
    v_lshl_add_u32 v6, v3, 2, v5
    v_lshlrev_b32 v6, 13, v6
    v_lshl_or_b32 v6, v11, 4, v6
    s_mov_b32 s8, 0xaaaaaaaa
    s_mov_b32 s9, 0xaaaaaaaa
    v_mov_b32 v11, 1
    v_mov_b32 v19, 131584
    v_and_b32 v18, 31, v0
    v_lshlrev_b32 v8, 4, v18
    v_and_b32 v16, 3, v0
    v_lshlrev_b32 v16, 5, v16
    v_and_b32 v18, 28, v0
    v_add3_u32 v16, v16, v18, v19
    v_lshlrev_b32 v17, 5, v5
    v_add_u32 v17, v17, v19
    s_mov_b32 s64, SPIN
L_gt_9:
    ds_read_b96 v[56:58], v7 offset:16
    s_waitcnt lgkmcnt(0)
    v_cmp_eq_u32 vcc, 0, v58
    s_cbranch_vccz L_gt_9_ok
    s_sleep 10
    s_sub_u32 s64, s64, 1
    s_cbranch_scc1 L_end
    s_branch L_gt_9
L_gt_9_ok:
    v_readfirstlane_b32 s40, v56
    v_readfirstlane_b32 s41, v57
    s_nop 1
    s_mov_b64 s[16:17], -1
    s_mov_b64 s[18:19], -1
    s_mov_b64 s[20:21], -1
    s_mov_b64 s[22:23], -1
    s_mov_b64 s[24:25], -1
    s_mov_b64 s[26:27], -1
    s_mov_b64 s[28:29], -1
    s_mov_b64 s[30:31], -1
    s_mov_b64 s[32:33], -1
    s_mov_b64 s[34:35], -1
    s_mov_b64 s[36:37], -1
    s_mov_b64 s[38:39], -1
    s_mov_b64 s[44:45], -1
    s_mov_b64 s[46:47], -1
    s_mov_b64 s[48:49], -1
    s_mov_b64 s[50:51], -1
    s_mov_b64 s[52:53], -1
    s_mov_b64 s[54:55], -1
    s_mov_b32 s65, 0
    s_mov_b32 s66, 0
    s_mov_b32 s64, SPIN
L_w_10:
    ds_read_b32 v59, v7 offset:28
    s_waitcnt lgkmcnt(0)
    v_cmp_gt_u32 vcc, 1, v59
    s_cbranch_vccz L_w_10_ok
    s_sleep 3
    s_sub_u32 s64, s64, 1
    s_cbranch_scc1 L_end
    s_branch L_w_10
L_w_10_ok:
    s_mov_b32 s64, SPIN
L_w_11:
    ds_read_b32 v59, v7 offset:0
    s_waitcnt lgkmcnt(0)
    v_cmp_gt_u32 vcc, 0x50, v59
    s_cbranch_vccz L_w_11_ok
    s_sleep 1
    s_sub_u32 s64, s64, 1
    s_cbranch_scc1 L_end
    s_branch L_w_11
L_w_11_ok:
    s_setprio 3
    s_mov_b64 exec, s[52:53]
    buffer_load_dwordx4 v[204:207], v8, s[56:59], s10 offen sc1
    s_mov_b64 exec, s[16:17]
    buffer_load_dwordx4 v[128:131], v2, s[56:59], s11 offen offset:0 sc1
    s_mov_b64 exec, s[18:19]
    buffer_load_dwordx4 v[132:135], v2, s[56:59], s11 offen offset:1024 sc1
    s_mov_b64 exec, s[20:21]
    buffer_load_dwordx4 v[136:139], v2, s[56:59], s11 offen offset:2048 sc1
    s_mov_b64 exec, s[22:23]
    buffer_load_dwordx4 v[140:143], v2, s[56:59], s11 offen offset:3072 sc1
    s_mov_b64 exec, s[24:25]
    buffer_load_dwordx4 v[144:147], v2, s[56:59], s12 offen offset:0 sc1
    s_mov_b64 exec, s[26:27]
    buffer_load_dwordx4 v[148:151], v2, s[56:59], s12 offen offset:1024 sc1
    s_mov_b64 exec, s[28:29]
    buffer_load_dwordx4 v[152:155], v2, s[56:59], s12 offen offset:2048 sc1
    s_mov_b64 exec, s[30:31]
    buffer_load_dwordx4 v[156:159], v2, s[56:59], s12 offen offset:3072 sc1
    s_mov_b64 exec, -1
    s_sleep 8
    s_mov_b64 exec, s[54:55]
    buffer_load_dwordx4 v[208:211], v8, s[56:59], s10 offen sc1
    s_mov_b64 exec, s[32:33]
    buffer_load_dwordx4 v[160:163], v2, s[56:59], s11 offen offset:0 sc1
    s_mov_b64 exec, s[34:35]
    buffer_load_dwordx4 v[164:167], v2, s[56:59], s11 offen offset:1024 sc1
    s_mov_b64 exec, s[36:37]
    buffer_load_dwordx4 v[168:171], v2, s[56:59], s11 offen offset:2048 sc1
    s_mov_b64 exec, s[38:39]
    buffer_load_dwordx4 v[172:175], v2, s[56:59], s11 offen offset:3072 sc1
    s_mov_b64 exec, s[44:45]
    buffer_load_dwordx4 v[176:179], v2, s[56:59], s12 offen offset:0 sc1
    s_mov_b64 exec, s[46:47]
    buffer_load_dwordx4 v[180:183], v2, s[56:59], s12 offen offset:1024 sc1
    s_mov_b64 exec, s[48:49]
    buffer_load_dwordx4 v[184:187], v2, s[56:59], s12 offen offset:2048 sc1
    s_mov_b64 exec, s[50:51]
    buffer_load_dwordx4 v[188:191], v2, s[56:59], s12 offen offset:3072 sc1
    s_mov_b64 exec, -1
    s_mov_b32 s64, SPIN
L_o_poll:
    s_cmp_lg_u32 s65, 0
    s_cbranch_scc1 L_o_np
    ds_read_b32 v59, v7 offset:0
    s_waitcnt lgkmcnt(0)
    v_cmp_gt_u32 vcc, 0x70, v59
    s_cbranch_vccnz L_o_np
    ds_read_b64_tr_b16 v[64:65], v12 offset:0
    ds_read_b64_tr_b16 v[66:67], v12 offset:2048
    ds_read_b64_tr_b16 v[68:69], v12 offset:8
    ds_read_b64_tr_b16 v[70:71], v12 offset:2056
    ds_read_b64_tr_b16 v[72:73], v13 offset:0
    ds_read_b64_tr_b16 v[74:75], v13 offset:2048
    ds_read_b64_tr_b16 v[76:77], v13 offset:8
    ds_read_b64_tr_b16 v[78:79], v13 offset:2056
    ds_read_b64_tr_b16 v[80:81], v14 offset:0
    ds_read_b64_tr_b16 v[82:83], v14 offset:2048
    ds_read_b64_tr_b16 v[84:85], v14 offset:8
    ds_read_b64_tr_b16 v[86:87], v14 offset:2056
    ds_read_b64_tr_b16 v[88:89], v15 offset:0
    ds_read_b64_tr_b16 v[90:91], v15 offset:2048
    ds_read_b64_tr_b16 v[92:93], v15 offset:8
    ds_read_b64_tr_b16 v[94:95], v15 offset:2056
    ds_read_b64_tr_b16 v[96:97], v12 offset:256
    ds_read_b64_tr_b16 v[98:99], v12 offset:2304
    ds_read_b64_tr_b16 v[100:101], v12 offset:264
    ds_read_b64_tr_b16 v[102:103], v12 offset:2312
    ds_read_b64_tr_b16 v[104:105], v13 offset:256
    ds_read_b64_tr_b16 v[106:107], v13 offset:2304
    ds_read_b64_tr_b16 v[108:109], v13 offset:264
    ds_read_b64_tr_b16 v[110:111], v13 offset:2312
    ds_read_b64_tr_b16 v[112:113], v14 offset:256
    ds_read_b64_tr_b16 v[114:115], v14 offset:2304
    ds_read_b64_tr_b16 v[116:117], v14 offset:264
    ds_read_b64_tr_b16 v[118:119], v14 offset:2312
    ds_read_b64_tr_b16 v[120:121], v15 offset:256
    ds_read_b64_tr_b16 v[122:123], v15 offset:2304
    ds_read_b64_tr_b16 v[124:125], v15 offset:264
    ds_read_b64_tr_b16 v[126:127], v15 offset:2312
    s_mov_b32 s65, 1
L_o_np:
    s_waitcnt vmcnt(9)
    s_cmp_lg_u32 s66, 0
    s_cbranch_scc1 L_o_ns0
    v_cmp_ne_u64 vcc, s[40:41], v[206:207]
    s_mov_b64 s[52:53], vcc
    s_cbranch_vccnz L_o_ns0
    v_mov_b32 v56, v204
    s_nop 1
    v_max_f32_dpp v56, v56, v56 row_ror:1 row_mask:0xf bank_mask:0xf
    s_nop 1
    v_max_f32_dpp v56, v56, v56 row_ror:2 row_mask:0xf bank_mask:0xf
    s_nop 1
    v_max_f32_dpp v56, v56, v56 row_ror:4 row_mask:0xf bank_mask:0xf
    s_nop 1
    v_max_f32_dpp v56, v56, v56 row_ror:8 row_mask:0xf bank_mask:0xf
    v_mov_b32 v57, v56
    s_nop 1
    v_permlane16_swap_b32 v56, v57
    v_max_f32 v56, v56, v57
    v_mov_b32 v57, v56
    s_nop 1
    v_permlane32_swap_b32 v56, v57
    v_max_f32 v56, v56, v57
    v_sub_f32 v56, v204, v56
    v_exp_f32 v56, v56
    s_mov_b32 s66, 1
    v_mul_f32 v57, v56, v205
    ds_write_b32 v16, v56
    ds_read_b128 v[48:51], v17
    ds_read_b128 v[52:55], v17 offset:16
    s_nop 1
    v_add_f32_dpp v57, v57, v57 row_ror:1 row_mask:0xf bank_mask:0xf
    s_nop 1
    v_add_f32_dpp v57, v57, v57 row_ror:2 row_mask:0xf bank_mask:0xf
    s_nop 1
    v_add_f32_dpp v57, v57, v57 row_ror:4 row_mask:0xf bank_mask:0xf
    s_nop 1
    v_add_f32_dpp v57, v57, v57 row_ror:8 row_mask:0xf bank_mask:0xf
    v_mov_b32 v58, v57
    s_nop 1
    v_permlane16_swap_b32 v57, v58
    v_add_f32 v57, v57, v58
    v_mov_b32 v58, v57
    s_nop 1
    v_permlane32_swap_b32 v57, v58
    v_add_f32 v57, v57, v58
    v_mul_f32 v57, 0.5, v57
    v_rcp_f32 v58, v57
    s_mov_b64 s[54:55], 0
    s_waitcnt lgkmcnt(0)
L_o_ns0:
    v_cmp_ne_u64 s[16:17], s[40:41], v[130:131]
    v_cmp_ne_u64 s[18:19], s[40:41], v[134:135]
    v_cmp_ne_u64 s[20:21], s[40:41], v[138:139]
    v_cmp_ne_u64 s[22:23], s[40:41], v[142:143]
    v_cmp_ne_u64 s[24:25], s[40:41], v[146:147]
    v_cmp_ne_u64 s[26:27], s[40:41], v[150:151]
    v_cmp_ne_u64 s[28:29], s[40:41], v[154:155]
    v_cmp_ne_u64 s[30:31], s[40:41], v[158:159]
    s_or_b64 s[60:61], s[16:17], 0
    s_or_b64 s[60:61], s[18:19], s[60:61]
    s_or_b64 s[60:61], s[20:21], s[60:61]
    s_or_b64 s[60:61], s[22:23], s[60:61]
    s_or_b64 s[60:61], s[24:25], s[60:61]
    s_or_b64 s[60:61], s[26:27], s[60:61]
    s_or_b64 s[60:61], s[28:29], s[60:61]
    s_or_b64 s[60:61], s[30:31], s[60:61]
    s_or_b64 s[60:61], s[52:53], s[60:61]
    s_cbranch_scc0 L_o_d0
    s_mov_b64 exec, s[52:53]
    buffer_load_dwordx4 v[204:207], v8, s[56:59], s10 offen sc1
    s_mov_b64 exec, s[16:17]
    buffer_load_dwordx4 v[128:131], v2, s[56:59], s11 offen offset:0 sc1
    s_mov_b64 exec, s[18:19]
    buffer_load_dwordx4 v[132:135], v2, s[56:59], s11 offen offset:1024 sc1
    s_mov_b64 exec, s[20:21]
    buffer_load_dwordx4 v[136:139], v2, s[56:59], s11 offen offset:2048 sc1
    s_mov_b64 exec, s[22:23]
    buffer_load_dwordx4 v[140:143], v2, s[56:59], s11 offen offset:3072 sc1
    s_mov_b64 exec, s[24:25]
    buffer_load_dwordx4 v[144:147], v2, s[56:59], s12 offen offset:0 sc1
    s_mov_b64 exec, s[26:27]
    buffer_load_dwordx4 v[148:151], v2, s[56:59], s12 offen offset:1024 sc1
    s_mov_b64 exec, s[28:29]
    buffer_load_dwordx4 v[152:155], v2, s[56:59], s12 offen offset:2048 sc1
    s_mov_b64 exec, s[30:31]
    buffer_load_dwordx4 v[156:159], v2, s[56:59], s12 offen offset:3072 sc1
    s_mov_b64 exec, -1
    s_waitcnt vmcnt(9)
    s_cmp_lg_u32 s66, 0
    s_cbranch_scc1 L_o_ns1
    v_cmp_ne_u64 vcc, s[40:41], v[210:211]
    s_mov_b64 s[54:55], vcc
    s_cbranch_vccnz L_o_ns1
    v_mov_b32 v56, v208
    s_nop 1
    v_max_f32_dpp v56, v56, v56 row_ror:1 row_mask:0xf bank_mask:0xf
    s_nop 1
    v_max_f32_dpp v56, v56, v56 row_ror:2 row_mask:0xf bank_mask:0xf
    s_nop 1
    v_max_f32_dpp v56, v56, v56 row_ror:4 row_mask:0xf bank_mask:0xf
    s_nop 1
    v_max_f32_dpp v56, v56, v56 row_ror:8 row_mask:0xf bank_mask:0xf
    v_mov_b32 v57, v56
    s_nop 1
    v_permlane16_swap_b32 v56, v57
    v_max_f32 v56, v56, v57
    v_mov_b32 v57, v56
    s_nop 1
    v_permlane32_swap_b32 v56, v57
    v_max_f32 v56, v56, v57
    v_sub_f32 v56, v208, v56
    v_exp_f32 v56, v56
    s_mov_b32 s66, 1
    v_mul_f32 v57, v56, v209
    ds_write_b32 v16, v56
    ds_read_b128 v[48:51], v17
    ds_read_b128 v[52:55], v17 offset:16
    s_nop 1
    v_add_f32_dpp v57, v57, v57 row_ror:1 row_mask:0xf bank_mask:0xf
    s_nop 1
    v_add_f32_dpp v57, v57, v57 row_ror:2 row_mask:0xf bank_mask:0xf
    s_nop 1
    v_add_f32_dpp v57, v57, v57 row_ror:4 row_mask:0xf bank_mask:0xf
    s_nop 1
    v_add_f32_dpp v57, v57, v57 row_ror:8 row_mask:0xf bank_mask:0xf
    v_mov_b32 v58, v57
    s_nop 1
    v_permlane16_swap_b32 v57, v58
    v_add_f32 v57, v57, v58
    v_mov_b32 v58, v57
    s_nop 1
    v_permlane32_swap_b32 v57, v58
    v_add_f32 v57, v57, v58
    v_mul_f32 v57, 0.5, v57
    v_rcp_f32 v58, v57
    s_mov_b64 s[52:53], 0
    s_waitcnt lgkmcnt(0)
L_o_ns1:
    v_cmp_ne_u64 s[32:33], s[40:41], v[162:163]
    v_cmp_ne_u64 s[34:35], s[40:41], v[166:167]
    v_cmp_ne_u64 s[36:37], s[40:41], v[170:171]
    v_cmp_ne_u64 s[38:39], s[40:41], v[174:175]
    v_cmp_ne_u64 s[44:45], s[40:41], v[178:179]
    v_cmp_ne_u64 s[46:47], s[40:41], v[182:183]
    v_cmp_ne_u64 s[48:49], s[40:41], v[186:187]
    v_cmp_ne_u64 s[50:51], s[40:41], v[190:191]
    s_or_b64 s[60:61], s[32:33], 0
    s_or_b64 s[60:61], s[34:35], s[60:61]
    s_or_b64 s[60:61], s[36:37], s[60:61]
    s_or_b64 s[60:61], s[38:39], s[60:61]
    s_or_b64 s[60:61], s[44:45], s[60:61]
    s_or_b64 s[60:61], s[46:47], s[60:61]
    s_or_b64 s[60:61], s[48:49], s[60:61]
    s_or_b64 s[60:61], s[50:51], s[60:61]
    s_or_b64 s[60:61], s[54:55], s[60:61]
    s_cbranch_scc0 L_o_d1
    s_mov_b64 exec, s[54:55]
    buffer_load_dwordx4 v[208:211], v8, s[56:59], s10 offen sc1
    s_mov_b64 exec, s[32:33]
    buffer_load_dwordx4 v[160:163], v2, s[56:59], s11 offen offset:0 sc1
    s_mov_b64 exec, s[34:35]
    buffer_load_dwordx4 v[164:167], v2, s[56:59], s11 offen offset:1024 sc1
    s_mov_b64 exec, s[36:37]
    buffer_load_dwordx4 v[168:171], v2, s[56:59], s11 offen offset:2048 sc1
    s_mov_b64 exec, s[38:39]
    buffer_load_dwordx4 v[172:175], v2, s[56:59], s11 offen offset:3072 sc1
    s_mov_b64 exec, s[44:45]
    buffer_load_dwordx4 v[176:179], v2, s[56:59], s12 offen offset:0 sc1
    s_mov_b64 exec, s[46:47]
    buffer_load_dwordx4 v[180:183], v2, s[56:59], s12 offen offset:1024 sc1
    s_mov_b64 exec, s[48:49]
    buffer_load_dwordx4 v[184:187], v2, s[56:59], s12 offen offset:2048 sc1
    s_mov_b64 exec, s[50:51]
    buffer_load_dwordx4 v[188:191], v2, s[56:59], s12 offen offset:3072 sc1
    s_mov_b64 exec, -1
    s_sub_u32 s64, s64, 1
    s_cbranch_scc1 L_end
    s_branch L_o_poll
L_o_d0:
    v_mul_f32 v60, v48, v128
    v_mul_f32 v61, v48, v129
    v_mul_f32 v62, v49, v132
    v_mul_f32 v63, v49, v133
    v_fmac_f32 v60, v50, v136
    v_fmac_f32 v61, v50, v137
    v_fmac_f32 v62, v51, v140
    v_fmac_f32 v63, v51, v141
    v_fmac_f32 v60, v52, v144
    v_fmac_f32 v61, v52, v145
    v_fmac_f32 v62, v53, v148
    v_fmac_f32 v63, v53, v149
    v_fmac_f32 v60, v54, v152
    v_fmac_f32 v61, v54, v153
    v_fmac_f32 v62, v55, v156
    v_fmac_f32 v63, v55, v157
    s_branch L_o_dd
L_o_d1:
    v_mul_f32 v60, v48, v160
    v_mul_f32 v61, v48, v161
    v_mul_f32 v62, v49, v164
    v_mul_f32 v63, v49, v165
    v_fmac_f32 v60, v50, v168
    v_fmac_f32 v61, v50, v169
    v_fmac_f32 v62, v51, v172
    v_fmac_f32 v63, v51, v173
    v_fmac_f32 v60, v52, v176
    v_fmac_f32 v61, v52, v177
    v_fmac_f32 v62, v53, v180
    v_fmac_f32 v63, v53, v181
    v_fmac_f32 v60, v54, v184
    v_fmac_f32 v61, v54, v185
    v_fmac_f32 v62, v55, v188
    v_fmac_f32 v63, v55, v189
L_o_dd:
    ds_write_b32 v7, v11 offset:40
    v_add_f32 v60, v60, v62
    v_add_f32 v61, v61, v63
    v_mov_b32 v62, v60
    v_mov_b32 v63, v61
    s_nop 1
    v_permlane16_swap_b32 v60, v62
    v_permlane16_swap_b32 v61, v63
    v_add_f32 v60, v60, v62
    v_add_f32 v61, v61, v63
    v_mov_b32 v62, v60
    v_mov_b32 v63, v61
    s_nop 1
    v_permlane32_swap_b32 v60, v62
    v_permlane32_swap_b32 v61, v63
    v_add_f32 v60, v60, v62
    v_add_f32 v61, v61, v63
    v_mul_f32 v62, v60, v58
    v_fma_f32 v63, -v62, v57, v60
    v_fma_f32 v60, v63, v58, v62
    v_mul_f32 v62, v61, v58
    v_fma_f32 v63, -v62, v57, v61
    v_fma_f32 v61, v63, v58, v62
    v_cvt_pk_bf16_f32 v60, v60, v61
    ds_write_b32 v9, v60
    ds_read_b128 v[16:19], v10 offset:448
    ds_read_b128 v[20:23], v10 offset:384
    ds_read_b128 v[24:27], v10 offset:320
    ds_read_b128 v[28:31], v10 offset:256
    ds_read_b128 v[32:35], v10 offset:192
    ds_read_b128 v[36:39], v10 offset:128
    ds_read_b128 v[40:43], v10 offset:64
    ds_read_b128 v[44:47], v10 offset:0
    s_cmp_lg_u32 s65, 0
    s_cbranch_scc1 L_o_have
    s_mov_b32 s64, SPIN
L_w_12:
    ds_read_b32 v59, v7 offset:0
    s_waitcnt lgkmcnt(0)
    v_cmp_gt_u32 vcc, 0x70, v59
    s_cbranch_vccz L_w_12_ok
    s_sub_u32 s64, s64, 1
    s_cbranch_scc1 L_end
    s_branch L_w_12
L_w_12_ok:
    ds_read_b64_tr_b16 v[64:65], v12 offset:0
    ds_read_b64_tr_b16 v[66:67], v12 offset:2048
    ds_read_b64_tr_b16 v[68:69], v12 offset:8
    ds_read_b64_tr_b16 v[70:71], v12 offset:2056
    ds_read_b64_tr_b16 v[72:73], v13 offset:0
    ds_read_b64_tr_b16 v[74:75], v13 offset:2048
    ds_read_b64_tr_b16 v[76:77], v13 offset:8
    ds_read_b64_tr_b16 v[78:79], v13 offset:2056
    ds_read_b64_tr_b16 v[80:81], v14 offset:0
    ds_read_b64_tr_b16 v[82:83], v14 offset:2048
    ds_read_b64_tr_b16 v[84:85], v14 offset:8
    ds_read_b64_tr_b16 v[86:87], v14 offset:2056
    ds_read_b64_tr_b16 v[88:89], v15 offset:0
    ds_read_b64_tr_b16 v[90:91], v15 offset:2048
    ds_read_b64_tr_b16 v[92:93], v15 offset:8
    ds_read_b64_tr_b16 v[94:95], v15 offset:2056
    ds_read_b64_tr_b16 v[96:97], v12 offset:256
    ds_read_b64_tr_b16 v[98:99], v12 offset:2304
    ds_read_b64_tr_b16 v[100:101], v12 offset:264
    ds_read_b64_tr_b16 v[102:103], v12 offset:2312
    ds_read_b64_tr_b16 v[104:105], v13 offset:256
    ds_read_b64_tr_b16 v[106:107], v13 offset:2304
    ds_read_b64_tr_b16 v[108:109], v13 offset:264
    ds_read_b64_tr_b16 v[110:111], v13 offset:2312
    ds_read_b64_tr_b16 v[112:113], v14 offset:256
    ds_read_b64_tr_b16 v[114:115], v14 offset:2304
    ds_read_b64_tr_b16 v[116:117], v14 offset:264
    ds_read_b64_tr_b16 v[118:119], v14 offset:2312
    ds_read_b64_tr_b16 v[120:121], v15 offset:256
    ds_read_b64_tr_b16 v[122:123], v15 offset:2304
    ds_read_b64_tr_b16 v[124:125], v15 offset:264
    ds_read_b64_tr_b16 v[126:127], v15 offset:2312
L_o_have:
    v_mov_b32 v194, s40
    v_mov_b32 v195, s41
    v_mov_b32 v198, s40
    v_mov_b32 v199, s41
    s_waitcnt lgkmcnt(0)
    v_mfma_f32_16x16x32_bf16 v[48:51], v[64:67], v[16:19], 0
    v_mfma_f32_16x16x32_bf16 v[52:55], v[96:99], v[16:19], 0
    v_mfma_f32_16x16x32_bf16 v[48:51], v[68:71], v[20:23], v[48:51]
    v_mfma_f32_16x16x32_bf16 v[52:55], v[100:103], v[20:23], v[52:55]
    v_mfma_f32_16x16x32_bf16 v[48:51], v[72:75], v[24:27], v[48:51]
    v_mfma_f32_16x16x32_bf16 v[52:55], v[104:107], v[24:27], v[52:55]
    v_mfma_f32_16x16x32_bf16 v[48:51], v[76:79], v[28:31], v[48:51]
    v_mfma_f32_16x16x32_bf16 v[52:55], v[108:111], v[28:31], v[52:55]
    v_mfma_f32_16x16x32_bf16 v[48:51], v[80:83], v[32:35], v[48:51]
    v_mfma_f32_16x16x32_bf16 v[52:55], v[112:115], v[32:35], v[52:55]
    v_mfma_f32_16x16x32_bf16 v[48:51], v[84:87], v[36:39], v[48:51]
    v_mfma_f32_16x16x32_bf16 v[52:55], v[116:119], v[36:39], v[52:55]
    v_mfma_f32_16x16x32_bf16 v[48:51], v[88:91], v[40:43], v[48:51]
    v_mfma_f32_16x16x32_bf16 v[52:55], v[120:123], v[40:43], v[52:55]
    v_mfma_f32_16x16x32_bf16 v[48:51], v[92:95], v[44:47], v[48:51]
    v_mfma_f32_16x16x32_bf16 v[52:55], v[124:127], v[44:47], v[52:55]
    s_nop 6
    v_cndmask_b32_e64 v192, v48, v50, s[8:9]
    v_cndmask_b32_e64 v193, v49, v51, s[8:9]
    v_cndmask_b32_e64 v196, v52, v54, s[8:9]
    v_cndmask_b32_e64 v197, v53, v55, s[8:9]
    buffer_store_dwordx4 v[192:195], v6, s[56:59], s14 offen sc1
    buffer_store_dwordx4 v[196:199], v6, s[56:59], s15 offen sc1
    ds_write_b32 v7, v11 offset:32
    s_endpgm
.p2align 12
L_f:
    s_and_b32 s14, s4, 3
    s_mul_i32 s14, s14, 14
    s_lshr_b32 s36, s4, 2
    s_lshl_b32 s7, s36, 3
    s_add_u32 s14, s14, s7
    s_lshr_b32 s7, s5, 2
    s_add_u32 s14, s14, s7
    s_and_b32 s15, s5, 3
    s_lshl_b32 s36, s36, 3
    s_add_u32 s36, s36, s5
    s_cmp_lt_u32 s36, 32
    s_cselect_b32 s36, 1, 0
    s_cbranch_scc1 L_f_go
    s_mov_b32 s48, s16
    s_mov_b32 s49, s17
    s_mov_b32 s50, 0x400
    s_mov_b32 s51, 0x20000
    s_mov_b32 s52, s34
    s_mov_b32 s53, s35
    s_mov_b32 s54, 0x400
    s_mov_b32 s55, 0x20000
    v_lshlrev_b32 v2, 4, v0
    s_mov_b32 s64, SPIN
L_gt_13:
    ds_read_b96 v[42:44], v7 offset:16
    s_waitcnt lgkmcnt(0)
    v_cmp_eq_u32 vcc, 0, v44
    s_cbranch_vccz L_gt_13_ok
    s_sleep 10
    s_sub_u32 s64, s64, 1
    s_cbranch_scc1 L_end
    s_branch L_gt_13
L_gt_13_ok:
    v_readfirstlane_b32 s40, v42
    v_readfirstlane_b32 s41, v43
    s_nop 1
    s_branch L_fin
L_f_go:
    s_lshl_b32 s6, s15, 8
    s_add_u32 s6, s6, 122880
    v_lshlrev_b32 v13, 4, v5
    v_add_u32 v13, s6, v13
    v_lshrrev_b32 v3, 2, v4
    v_lshl_add_u32 v3, v5, 3, v3
    v_lshlrev_b32 v3, 7, v3
    v_bfe_u32 v6, v0, 3, 2
    v_lshl_or_b32 v3, v6, 5, v3
    v_and_b32 v6, 3, v0
    v_lshl_or_b32 v52, v6, 3, v3
    v_add_u32 v52, 81920, v52
    v_xor_b32 v53, 32, v52
    v_xor_b32 v54, 64, v52
    v_xor_b32 v55, 96, v52
    v_lshrrev_b32 v3, 2, v4
    v_lshl_add_u32 v2, v5, 3, v3
    v_lshlrev_b32 v2, 8, v2
    v_add_u32 v2, 114688, v2
    v_and_b32 v12, 3, v0
    v_xor_b32 v16, 0, v3
    v_lshl_or_b32 v16, v16, 2, v12
    v_lshl_add_u32 v8, v16, 4, v2
    v_xor_b32 v16, 1, v3
    v_lshl_or_b32 v16, v16, 2, v12
    v_lshl_add_u32 v9, v16, 4, v2
    v_xor_b32 v16, 2, v3
    v_lshl_or_b32 v16, v16, 2, v12
    v_lshl_add_u32 v10, v16, 4, v2
    v_xor_b32 v16, 3, v3
    v_lshl_or_b32 v16, v16, 2, v12
    v_lshl_add_u32 v11, v16, 4, v2
    s_lshl_b32 s11, s14, 11
    s_add_u32 s11, s11, 0x5000
    s_and_b32 s6, s5, 7
    s_lshl_b32 s6, s6, 8
    s_lshr_b32 s10, s14, 1
    s_lshl_b32 s10, s10, 12
    s_add_u32 s10, s10, s6
    s_add_u32 s10, s10, 0x5000
    v_bfe_u32 v16, v0, 2, 1
    v_lshlrev_b32 v16, 11, v16
    v_lshl_or_b32 v16, v5, 6, v16
    v_lshl_or_b32 v16, v12, 4, v16
    v_lshlrev_b32 v2, 4, v0
    v_bfe_u32 v6, v0, 1, 1
    v_lshlrev_b32 v17, 5, v6
    v_lshl_or_b32 v17, v3, 3, v17
    v_and_b32 v6, 1, v0
    v_lshl_or_b32 v17, v6, 2, v17
    v_add_u32 v17, 130496, v17
    v_lshrrev_b32 v18, 1, v4
    v_lshlrev_b32 v18, 6, v18
    v_lshl_or_b32 v18, v5, 4, v18
    v_add_u32 v18, 130048, v18
    s_mul_i32 s12, s15, 57344
    s_lshl_b32 s6, s14, 6
    s_add_u32 s12, s12, s6
    s_add_u32 s12, s12, 0x41000
    v_lshl_add_u32 v19, v3, 2, v5
    v_mul_u32_u24 v19, 0xe00, v19
    v_lshl_or_b32 v19, v12, 4, v19
    s_mov_b32 s8, 0xaaaaaaaa
    s_mov_b32 s9, 0xaaaaaaaa
    v_bfe_u32 v6, v0, 1, 2
    s_mov_b32 s64, SPIN
L_gt_14:
    ds_read_b96 v[42:44], v7 offset:16
    s_waitcnt lgkmcnt(0)
    v_cmp_eq_u32 vcc, 0, v44
    s_cbranch_vccz L_gt_14_ok
    s_sleep 10
    s_sub_u32 s64, s64, 1
    s_cbranch_scc1 L_end
    s_branch L_gt_14
L_gt_14_ok:
    v_readfirstlane_b32 s40, v42
    v_readfirstlane_b32 s41, v43
    s_nop 1
    s_mov_b32 s64, SPIN
L_w_15:
    ds_read_b32 v20, v7 offset:4
    s_waitcnt lgkmcnt(0)
    v_cmp_gt_u32 vcc, 1, v20
    s_cbranch_vccz L_w_15_ok
    s_sleep 4
    s_sub_u32 s64, s64, 1
    s_cbranch_scc1 L_end
    s_branch L_w_15
L_w_15_ok:
    ds_read_b128 v[20:23], v13 offset:0
    ds_read_b128 v[24:27], v13 offset:64
    ds_read_b128 v[28:31], v13 offset:128
    ds_read_b128 v[32:35], v13 offset:192
    v_mov_b32 v36, 0
    s_waitcnt lgkmcnt(0)
    v_cmp_eq_u32 vcc, 0, v6
    s_nop 1
    v_cndmask_b32 v128, v36, v20, vcc
    v_cndmask_b32 v129, v36, v21, vcc
    v_cndmask_b32 v130, v36, v22, vcc
    v_cndmask_b32 v131, v36, v23, vcc
    v_cndmask_b32 v132, v36, v24, vcc
    v_cndmask_b32 v133, v36, v25, vcc
    v_cndmask_b32 v134, v36, v26, vcc
    v_cndmask_b32 v135, v36, v27, vcc
    v_cndmask_b32 v136, v36, v28, vcc
    v_cndmask_b32 v137, v36, v29, vcc
    v_cndmask_b32 v138, v36, v30, vcc
    v_cndmask_b32 v139, v36, v31, vcc
    v_cndmask_b32 v140, v36, v32, vcc
    v_cndmask_b32 v141, v36, v33, vcc
    v_cndmask_b32 v142, v36, v34, vcc
    v_cndmask_b32 v143, v36, v35, vcc
    v_cmp_eq_u32 vcc, 1, v6
    s_nop 1
    v_cndmask_b32 v144, v36, v20, vcc
    v_cndmask_b32 v145, v36, v21, vcc
    v_cndmask_b32 v146, v36, v22, vcc
    v_cndmask_b32 v147, v36, v23, vcc
    v_cndmask_b32 v148, v36, v24, vcc
    v_cndmask_b32 v149, v36, v25, vcc
    v_cndmask_b32 v150, v36, v26, vcc
    v_cndmask_b32 v151, v36, v27, vcc
    v_cndmask_b32 v152, v36, v28, vcc
    v_cndmask_b32 v153, v36, v29, vcc
    v_cndmask_b32 v154, v36, v30, vcc
    v_cndmask_b32 v155, v36, v31, vcc
    v_cndmask_b32 v156, v36, v32, vcc
    v_cndmask_b32 v157, v36, v33, vcc
    v_cndmask_b32 v158, v36, v34, vcc
    v_cndmask_b32 v159, v36, v35, vcc
    v_cmp_eq_u32 vcc, 2, v6
    s_nop 1
    v_cndmask_b32 v160, v36, v20, vcc
    v_cndmask_b32 v161, v36, v21, vcc
    v_cndmask_b32 v162, v36, v22, vcc
    v_cndmask_b32 v163, v36, v23, vcc
    v_cndmask_b32 v164, v36, v24, vcc
    v_cndmask_b32 v165, v36, v25, vcc
    v_cndmask_b32 v166, v36, v26, vcc
    v_cndmask_b32 v167, v36, v27, vcc
    v_cndmask_b32 v168, v36, v28, vcc
    v_cndmask_b32 v169, v36, v29, vcc
    v_cndmask_b32 v170, v36, v30, vcc
    v_cndmask_b32 v171, v36, v31, vcc
    v_cndmask_b32 v172, v36, v32, vcc
    v_cndmask_b32 v173, v36, v33, vcc
    v_cndmask_b32 v174, v36, v34, vcc
    v_cndmask_b32 v175, v36, v35, vcc
    v_cmp_eq_u32 vcc, 3, v6
    s_nop 1
    v_cndmask_b32 v176, v36, v20, vcc
    v_cndmask_b32 v177, v36, v21, vcc
    v_cndmask_b32 v178, v36, v22, vcc
    v_cndmask_b32 v179, v36, v23, vcc
    v_cndmask_b32 v180, v36, v24, vcc
    v_cndmask_b32 v181, v36, v25, vcc
    v_cndmask_b32 v182, v36, v26, vcc
    v_cndmask_b32 v183, v36, v27, vcc
    v_cndmask_b32 v184, v36, v28, vcc
    v_cndmask_b32 v185, v36, v29, vcc
    v_cndmask_b32 v186, v36, v30, vcc
    v_cndmask_b32 v187, v36, v31, vcc
    v_cndmask_b32 v188, v36, v32, vcc
    v_cndmask_b32 v189, v36, v33, vcc
    v_cndmask_b32 v190, v36, v34, vcc
    v_cndmask_b32 v191, v36, v35, vcc
    s_mov_b32 s64, SPIN
L_f_qw:
    ds_read_b32 v20, v7 offset:8
    s_waitcnt lgkmcnt(0)
    v_and_b32 v21, 7, v20
    v_cmp_ne_u32 vcc, 4, v21
    s_cbranch_vccz L_f_qok
    s_sleep 4
    s_sub_u32 s64, s64, 1
    s_cbranch_scc1 L_end
    s_branch L_f_qw
L_f_qok:
    v_readfirstlane_b32 s45, v20
    s_mov_b32 s64, SPIN
L_w_16:
    ds_read_b32 v20, v7 offset:0
    s_waitcnt lgkmcnt(0)
    v_cmp_gt_u32 vcc, 0x58, v20
    s_cbranch_vccz L_w_16_ok
    s_sleep 1
    s_sub_u32 s64, s64, 1
    s_cbranch_scc1 L_end
    s_branch L_w_16
L_w_16_ok:
    s_setprio 3
    ds_read_b64_tr_b16 v[64:65], v52 offset:0
    ds_read_b64_tr_b16 v[66:67], v52 offset:512
    ds_read_b64_tr_b16 v[68:69], v52 offset:4096
    ds_read_b64_tr_b16 v[70:71], v52 offset:4608
    ds_read_b64_tr_b16 v[80:81], v53 offset:0
    ds_read_b64_tr_b16 v[82:83], v53 offset:512
    ds_read_b64_tr_b16 v[84:85], v53 offset:4096
    ds_read_b64_tr_b16 v[86:87], v53 offset:4608
    ds_read_b64_tr_b16 v[96:97], v54 offset:0
    ds_read_b64_tr_b16 v[98:99], v54 offset:512
    ds_read_b64_tr_b16 v[100:101], v54 offset:4096
    ds_read_b64_tr_b16 v[102:103], v54 offset:4608
    ds_read_b64_tr_b16 v[112:113], v55 offset:0
    ds_read_b64_tr_b16 v[114:115], v55 offset:512
    ds_read_b64_tr_b16 v[116:117], v55 offset:4096
    ds_read_b64_tr_b16 v[118:119], v55 offset:4608
    s_waitcnt lgkmcnt(14)
    v_mfma_f32_16x16x32_bf16 v[36:39], v[64:67], v[128:131], 0
    s_waitcnt lgkmcnt(12)
    v_mfma_f32_16x16x32_bf16 v[36:39], v[68:71], v[132:135], v[36:39]
    s_waitcnt lgkmcnt(10)
    v_mfma_f32_16x16x32_bf16 v[36:39], v[80:83], v[144:147], v[36:39]
    s_waitcnt lgkmcnt(8)
    v_mfma_f32_16x16x32_bf16 v[36:39], v[84:87], v[148:151], v[36:39]
    s_waitcnt lgkmcnt(6)
    v_mfma_f32_16x16x32_bf16 v[36:39], v[96:99], v[160:163], v[36:39]
    s_waitcnt lgkmcnt(4)
    v_mfma_f32_16x16x32_bf16 v[36:39], v[100:103], v[164:167], v[36:39]
    s_waitcnt lgkmcnt(2)
    v_mfma_f32_16x16x32_bf16 v[36:39], v[112:115], v[176:179], v[36:39]
    s_waitcnt lgkmcnt(0)
    v_mfma_f32_16x16x32_bf16 v[36:39], v[116:119], v[180:183], v[36:39]
    s_mov_b32 s64, SPIN
L_w_17:
    ds_read_b32 v20, v7 offset:0
    s_waitcnt lgkmcnt(0)
    v_cmp_gt_u32 vcc, 0x60, v20
    s_cbranch_vccz L_w_17_ok
    s_sub_u32 s64, s64, 1
    s_cbranch_scc1 L_end
    s_branch L_w_17
L_w_17_ok:
    ds_read_b64_tr_b16 v[72:73], v52 offset:8192
    ds_read_b64_tr_b16 v[74:75], v52 offset:8704
    ds_read_b64_tr_b16 v[76:77], v52 offset:12288
    ds_read_b64_tr_b16 v[78:79], v52 offset:12800
    ds_read_b64_tr_b16 v[88:89], v53 offset:8192
    ds_read_b64_tr_b16 v[90:91], v53 offset:8704
    ds_read_b64_tr_b16 v[92:93], v53 offset:12288
    ds_read_b64_tr_b16 v[94:95], v53 offset:12800
    ds_read_b64_tr_b16 v[104:105], v54 offset:8192
    ds_read_b64_tr_b16 v[106:107], v54 offset:8704
    ds_read_b64_tr_b16 v[108:109], v54 offset:12288
    ds_read_b64_tr_b16 v[110:111], v54 offset:12800
    ds_read_b64_tr_b16 v[120:121], v55 offset:8192
    ds_read_b64_tr_b16 v[122:123], v55 offset:8704
    ds_read_b64_tr_b16 v[124:125], v55 offset:12288
    ds_read_b64_tr_b16 v[126:127], v55 offset:12800
    s_waitcnt lgkmcnt(14)
    v_mfma_f32_16x16x32_bf16 v[36:39], v[72:75], v[136:139], v[36:39]
    s_waitcnt lgkmcnt(12)
    v_mfma_f32_16x16x32_bf16 v[36:39], v[76:79], v[140:143], v[36:39]
    s_waitcnt lgkmcnt(10)
    v_mfma_f32_16x16x32_bf16 v[36:39], v[88:91], v[152:155], v[36:39]
    s_waitcnt lgkmcnt(8)
    v_mfma_f32_16x16x32_bf16 v[36:39], v[92:95], v[156:159], v[36:39]
    s_waitcnt lgkmcnt(6)
    v_mfma_f32_16x16x32_bf16 v[36:39], v[104:107], v[168:171], v[36:39]
    s_waitcnt lgkmcnt(4)
    v_mfma_f32_16x16x32_bf16 v[36:39], v[108:111], v[172:175], v[36:39]
    s_waitcnt lgkmcnt(2)
    v_mfma_f32_16x16x32_bf16 v[36:39], v[120:123], v[184:187], v[36:39]
    s_waitcnt lgkmcnt(0)
    v_mfma_f32_16x16x32_bf16 v[36:39], v[124:127], v[188:191], v[36:39]
    s_nop 7
    v_cndmask_b32_e64 v40, v36, v38, s[8:9]
    v_cndmask_b32_e64 v41, v37, v39, s[8:9]
    s_mov_b32 exec_lo, 0x00ff00ff
    s_mov_b32 exec_hi, 0x00ff00ff
    s_cmp_eq_u32 s45, 4
    s_cbranch_scc1 L_f_pf
    buffer_store_dwordx4 v[40:43], v16, s[56:59], s10 offen sc1
    s_branch L_f_p2
L_f_pf:
    buffer_store_dwordx4 v[40:43], v16, s[56:59], s10 offen
L_f_p2:
    s_mov_b64 exec, -1
    s_mov_b32 s65, 0
    buffer_load_dwordx4 v[20:23], v2, s[56:59], s11 offen sc1
    buffer_load_dwordx4 v[24:27], v2, s[56:59], s11 offen offset:1024 sc1
    s_sleep 4
    buffer_load_dwordx4 v[28:31], v2, s[56:59], s11 offen sc1
    buffer_load_dwordx4 v[32:35], v2, s[56:59], s11 offen offset:1024 sc1
    s_mov_b32 s64, SPIN
L_f_poll:
    s_cmp_lg_u32 s65, 0
    s_cbranch_scc1 L_f_np
    ds_read_b32 v44, v7 offset:0
    s_waitcnt lgkmcnt(0)
    v_cmp_gt_u32 vcc, 0x78, v44
    s_cbranch_vccnz L_f_np
    ds_read_b64_tr_b16 v[64:65], v8 offset:0
    ds_read_b64_tr_b16 v[66:67], v8 offset:1024
    ds_read_b64_tr_b16 v[68:69], v8 offset:8
    ds_read_b64_tr_b16 v[70:71], v8 offset:1032
    ds_read_b64_tr_b16 v[72:73], v9 offset:0
    ds_read_b64_tr_b16 v[74:75], v9 offset:1024
    ds_read_b64_tr_b16 v[76:77], v9 offset:8
    ds_read_b64_tr_b16 v[78:79], v9 offset:1032
    ds_read_b64_tr_b16 v[80:81], v10 offset:0
    ds_read_b64_tr_b16 v[82:83], v10 offset:1024
    ds_read_b64_tr_b16 v[84:85], v10 offset:8
    ds_read_b64_tr_b16 v[86:87], v10 offset:1032
    ds_read_b64_tr_b16 v[88:89], v11 offset:0
    ds_read_b64_tr_b16 v[90:91], v11 offset:1024
    ds_read_b64_tr_b16 v[92:93], v11 offset:8
    ds_read_b64_tr_b16 v[94:95], v11 offset:1032
    s_mov_b32 s65, 1
L_f_np:
    s_waitcnt vmcnt(2)
    v_cmp_ne_u64 vcc, s[40:41], v[22:23]
    v_cmp_ne_u64 s[60:61], s[40:41], v[26:27]
    s_or_b64 vcc, vcc, s[60:61]
    s_cbranch_vccz L_f_d0
    buffer_load_dwordx4 v[20:23], v2, s[56:59], s11 offen sc1
    buffer_load_dwordx4 v[24:27], v2, s[56:59], s11 offen offset:1024 sc1
    s_waitcnt vmcnt(2)
    v_cmp_ne_u64 vcc, s[40:41], v[30:31]
    v_cmp_ne_u64 s[60:61], s[40:41], v[34:35]
    s_or_b64 vcc, vcc, s[60:61]
    s_cbranch_vccz L_f_d1
    buffer_load_dwordx4 v[28:31], v2, s[56:59], s11 offen sc1
    buffer_load_dwordx4 v[32:35], v2, s[56:59], s11 offen offset:1024 sc1
    s_sub_u32 s64, s64, 1
    s_cbranch_scc1 L_end
    s_branch L_f_poll
L_f_d0:
    v_mov_b32 v44, v20
    v_mov_b32 v45, v21
    v_mov_b32 v46, v24
    v_mov_b32 v47, v25
    s_branch L_f_dd
L_f_d1:
    v_mov_b32 v44, v28
    v_mov_b32 v45, v29
    v_mov_b32 v46, v32
    v_mov_b32 v47, v33
L_f_dd:
    v_mov_b32 v48, v44
    v_mov_b32 v49, v45
    v_mov_b32 v50, v46
    v_mov_b32 v51, v47
    s_nop 0
    v_permlane16_swap_b32 v44, v48
    v_permlane16_swap_b32 v45, v49
    v_permlane16_swap_b32 v46, v50
    v_permlane16_swap_b32 v47, v51
    v_add_f32 v44, v44, v48
    v_add_f32 v45, v45, v49
    v_add_f32 v46, v46, v50
    v_add_f32 v47, v47, v51
    v_mov_b32 v48, v44
    v_mov_b32 v49, v45
    v_mov_b32 v50, v46
    v_mov_b32 v51, v47
    s_nop 0
    v_permlane32_swap_b32 v44, v48
    v_permlane32_swap_b32 v45, v49
    v_permlane32_swap_b32 v46, v50
    v_permlane32_swap_b32 v47, v51
    v_add_f32 v44, v44, v48
    v_add_f32 v45, v45, v49
    v_add_f32 v46, v46, v50
    v_add_f32 v47, v47, v51
    s_mov_b32 s16, 0x3d372713
    s_mov_b32 s17, 0xc0135761
    v_cvt_pk_bf16_f32 v48, v44, v45
    v_cvt_pk_bf16_f32 v49, v46, v47
    v_lshlrev_b32 v44, 16, v48
    v_and_b32 v45, 0xffff0000, v48
    v_lshlrev_b32 v46, 16, v49
    v_and_b32 v47, 0xffff0000, v49
    v_mul_f32 v48, v44, v44
    v_mul_f32 v49, v45, v45
    v_mul_f32 v48, v48, v44
    v_mul_f32 v49, v49, v45
    v_fma_f32 v48, v48, s16, v44
    v_fma_f32 v49, v49, s16, v45
    v_mul_f32 v48, s17, v48
    v_mul_f32 v49, s17, v49
    v_exp_f32 v48, v48
    v_exp_f32 v49, v49
    s_nop 0
    v_add_f32 v48, 1.0, v48
    v_add_f32 v49, 1.0, v49
    v_rcp_f32 v48, v48
    v_rcp_f32 v49, v49
    s_nop 0
    v_mul_f32 v44, v44, v48
    v_mul_f32 v45, v45, v49
    v_cvt_pk_bf16_f32 v48, v44, v45
    v_lshlrev_b32 v44, 16, v48
    v_and_b32 v45, 0xffff0000, v48
    v_mul_f32 v44, v44, v46
    v_mul_f32 v45, v45, v47
    v_cvt_pk_bf16_f32 v48, v44, v45
    ds_write_b32 v17, v48
    ds_read_b128 v[128:131], v18 offset:448
    ds_read_b128 v[132:135], v18 offset:384
    ds_read_b128 v[136:139], v18 offset:320
    ds_read_b128 v[140:143], v18 offset:256
    ds_read_b128 v[144:147], v18 offset:192
    ds_read_b128 v[148:151], v18 offset:128
    ds_read_b128 v[152:155], v18 offset:64
    ds_read_b128 v[156:159], v18 offset:0
    s_cmp_lg_u32 s65, 0
    s_cbranch_scc1 L_f_have
    s_mov_b32 s64, SPIN
L_w_18:
    ds_read_b32 v44, v7 offset:0
    s_waitcnt lgkmcnt(0)
    v_cmp_gt_u32 vcc, 0x78, v44
    s_cbranch_vccz L_w_18_ok
    s_sub_u32 s64, s64, 1
    s_cbranch_scc1 L_end
    s_branch L_w_18
L_w_18_ok:
    ds_read_b64_tr_b16 v[64:65], v8 offset:0
    ds_read_b64_tr_b16 v[66:67], v8 offset:1024
    ds_read_b64_tr_b16 v[68:69], v8 offset:8
    ds_read_b64_tr_b16 v[70:71], v8 offset:1032
    ds_read_b64_tr_b16 v[72:73], v9 offset:0
    ds_read_b64_tr_b16 v[74:75], v9 offset:1024
    ds_read_b64_tr_b16 v[76:77], v9 offset:8
    ds_read_b64_tr_b16 v[78:79], v9 offset:1032
    ds_read_b64_tr_b16 v[80:81], v10 offset:0
    ds_read_b64_tr_b16 v[82:83], v10 offset:1024
    ds_read_b64_tr_b16 v[84:85], v10 offset:8
    ds_read_b64_tr_b16 v[86:87], v10 offset:1032
    ds_read_b64_tr_b16 v[88:89], v11 offset:0
    ds_read_b64_tr_b16 v[90:91], v11 offset:1024
    ds_read_b64_tr_b16 v[92:93], v11 offset:8
    ds_read_b64_tr_b16 v[94:95], v11 offset:1032
L_f_have:
    s_waitcnt lgkmcnt(0)
    v_mfma_f32_16x16x32_bf16 v[36:39], v[64:67], v[128:131], 0
    v_mfma_f32_16x16x32_bf16 v[36:39], v[68:71], v[132:135], v[36:39]
    v_mfma_f32_16x16x32_bf16 v[36:39], v[72:75], v[136:139], v[36:39]
    v_mfma_f32_16x16x32_bf16 v[36:39], v[76:79], v[140:143], v[36:39]
    v_mfma_f32_16x16x32_bf16 v[36:39], v[80:83], v[144:147], v[36:39]
    v_mfma_f32_16x16x32_bf16 v[36:39], v[84:87], v[148:151], v[36:39]
    v_mfma_f32_16x16x32_bf16 v[36:39], v[88:91], v[152:155], v[36:39]
    v_mfma_f32_16x16x32_bf16 v[36:39], v[92:95], v[156:159], v[36:39]
    s_nop 7
    v_cndmask_b32_e64 v40, v36, v38, s[8:9]
    v_cndmask_b32_e64 v41, v37, v39, s[8:9]
    buffer_store_dwordx4 v[40:43], v19, s[56:59], s12 offen sc1
L_end:
    s_endpgm
.section .rodata,"a"
.p2align 6
.amdhsa_kernel recurrent_scan__sliding_block_cached__glu_gated_geglu__decode_kernel
  .amdhsa_next_free_vgpr 216
  .amdhsa_next_free_sgpr 102
  .amdhsa_accum_offset 216
  .amdhsa_group_segment_fixed_size 0
  .amdhsa_kernarg_size 96
  .amdhsa_user_sgpr_count 2
  .amdhsa_user_sgpr_kernarg_segment_ptr 1
  .amdhsa_system_sgpr_workgroup_id_x 1
  .amdhsa_float_denorm_mode_32 3
.end_amdhsa_kernel
```
